```python
import torch

def _softmax(x, axis=-1):
    return torch.softmax(x, dim=axis)
def _gelu(x):
    return torch.nn.functional.gelu(x, approximate="tanh")
def _silu(x):
    return torch.nn.functional.silu(x)
def _sigmoid(x):
    return torch.sigmoid(x)
def _layernorm(x, axis=-1, eps=1e-5):
    m = x.mean(dim=axis, keepdim=True)
    v = x.var(dim=axis, keepdim=True, unbiased=False)
    return (x - m) / torch.sqrt(v + eps)
def _scatter_add(tgt, idx, src, axis=0):
    return tgt.clone().index_add_(axis, idx, src)
def _segment_sum(src, seg, n):
    out = torch.zeros((n,) + src.shape[1:], dtype=src.dtype)
    return out.index_add_(0, seg, src)
def _pad(x, pw):
    flat = tuple(v for pair in reversed(pw) for v in pair)
    return torch.nn.functional.pad(x, flat)

kernel_name = 'concat_heads__softmax_full_mha__ssm_conv_s5__prompt'

def setup_inputs():

    _w = (lambda a: (lambda t: t.to(torch.bfloat16) if t.is_floating_point() else t)(torch.as_tensor(a)))
    def _A_setup():
        B, S, D = 1, 2048, 512
        return {
            "x": _w((lambda *s: torch.randn(*s, dtype=torch.bfloat16) * 0.2)(B, S, D)),
            "wqkv": _w((lambda *s: torch.randn(*s, dtype=torch.bfloat16) * 0.2)(D, 3 * D)),
            "wo": _w((lambda *s: torch.randn(*s, dtype=torch.bfloat16) * 0.05)(D, D)),
        }
    _A_in = _A_setup()

    def _B_setup():
        B, S, D = 1, 2048, 512
        P = D
        Lambda_re = -0.5 * (lambda _x: torch.exp(torch.as_tensor(_x)))((lambda *s: torch.randn(*s, dtype=torch.bfloat16) * 0.4)(P))
        Lambda_im = (lambda *s: torch.randn(*s, dtype=torch.bfloat16) * 0.8)(P) * 1.0
        B_re = (lambda *s: torch.randn(*s, dtype=torch.bfloat16) * 0.8)(P, D) * (D ** -0.5)
        B_im = (lambda *s: torch.randn(*s, dtype=torch.bfloat16) * 0.8)(P, D) * (D ** -0.5)
        C_re = (lambda *s: torch.randn(*s, dtype=torch.bfloat16) * 0.8)(D, P) * (P ** -0.5)
        C_im = (lambda *s: torch.randn(*s, dtype=torch.bfloat16) * 0.4)(D, P) * (P ** -0.5)
        log_dt = (lambda *s: torch.randn(*s, dtype=torch.bfloat16) * 0.4)(P) * 0.3 - 2.0
        Dskip = (lambda *s: torch.randn(*s, dtype=torch.bfloat16) * 0.1)(D)
        return {
            "x": _w((lambda *s: torch.randn(*s, dtype=torch.bfloat16) * 0.05)(B, S, D)),
            "Lambda_re": _w(Lambda_re),
            "Lambda_im": _w(Lambda_im),
            "B_re": _w(B_re),
            "B_im": _w(B_im),
            "C_re": _w(C_re),
            "C_im": _w(C_im),
            "log_dt": _w(log_dt),
            "Dskip": _w(Dskip),
        }
    _B_in = _B_setup()

    return {
        "A_x": _A_in["x"],
        "A_wqkv": _A_in["wqkv"],
        "A_wo": _A_in["wo"],
        "B_x": _B_in["x"],
        "B_Lambda_re": _B_in["Lambda_re"],
        "B_Lambda_im": _B_in["Lambda_im"],
        "B_B_re": _B_in["B_re"],
        "B_B_im": _B_in["B_im"],
        "B_C_re": _B_in["C_re"],
        "B_C_im": _B_in["C_im"],
        "B_log_dt": _B_in["log_dt"],
        "B_Dskip": _B_in["Dskip"],
    }

def reference(A_x, A_wqkv, A_wo, B_x, B_Lambda_re, B_Lambda_im, B_B_re, B_B_im, B_C_re, B_C_im, B_log_dt, B_Dskip):
    def _A_ref(x, wqkv, wo):
        B, S, D = x.shape
        H = 32; Dh = D // H
        qkv = (lambda x, *d: x.permute(*d))((x @ wqkv).reshape(B, S, 3, H, Dh), 2, 0, 3, 1, 4)
        q, k, v = qkv[0], qkv[1], qkv[2]
        scale = Dh ** -0.5
        scores = torch.einsum("bhqd,bhkd->bhqk", q, k) * scale
        p = _softmax(scores, axis=-1)
        o = torch.einsum("bhqk,bhkd->bhqd", p, v)
        return (lambda x, *d: x.permute(*d))(o, 0, 2, 1, 3).reshape(B, S, D) @ wo

    def _B_ref(x, Lambda_re, Lambda_im, B_re, B_im, C_re, C_im, log_dt, Dskip):
        Bsz, L, H = x.shape
        Lam = Lambda_re + 1j * Lambda_im
        Bmat = B_re + 1j * B_im
        Cmat = C_re + 1j * C_im
        dt = torch.exp(log_dt)
        Lam_bar = torch.exp(dt * Lam)
        B_bar = ((Lam_bar - 1.0) / Lam)[:, None] * Bmat
        Bu = torch.einsum("bld,pd->blp", x + 0j, B_bar)
        h = torch.zeros_like(Bu[:, 0, :])
        hs = []
        for t in range(L):
            h = Lam_bar[None, :] * h + Bu[:, t, :]
            hs.append(h)
        hseq = torch.stack(hs, 1)
        y = 2.0 * torch.einsum("blp,dp->bld", hseq, Cmat).real + x * Dskip[None, None, :]
        return y

    a = _A_ref(A_x, A_wqkv, A_wo)
    b = _B_ref(B_x, B_Lambda_re, B_Lambda_im, B_B_re, B_B_im, B_C_re, B_C_im, B_log_dt, B_Dskip)
    return torch.concatenate([a, b], axis=-1)
```

```asm
; @launch grid=(512,1,1) block=(512,1,1) lds=81920
.amdgcn_target "amdgcn-amd-amdhsa--gfx950"
.text
.globl concat_heads__softmax_full_mha__ssm_conv_s5__prompt_kernel
.p2align 8
.type concat_heads__softmax_full_mha__ssm_conv_s5__prompt_kernel,@function
concat_heads__softmax_full_mha__ssm_conv_s5__prompt_kernel:
    s_cmp_ge_u32 s2, 512
    s_cbranch_scc1 L_end
    v_lshrrev_b32 v1, 6, v0
    v_and_b32 v0, 63, v0
    v_readfirstlane_b32 s3, v1
    s_cmp_ge_u32 s2, 256
    s_cbranch_scc1 L_B
    s_load_dwordx2 s[8:9], s[0:1], 0
    s_load_dwordx2 s[12:13], s[0:1], 8
    s_load_dwordx2 s[20:21], s[0:1], 16
    s_load_dwordx2 s[24:25], s[0:1], 96
    s_load_dwordx2 s[28:29], s[0:1], 104
    s_load_dwordx2 s[16:17], s[0:1], 112
    s_mov_b32 s10, 0x200000
    s_mov_b32 s11, 0x00020000
    s_mov_b32 s14, 0x180000
    s_mov_b32 s15, 0x00020000
    s_mov_b32 s22, 0x80000
    s_mov_b32 s23, 0x00020000
    s_mov_b32 s26, 0x800000
    s_mov_b32 s27, 0x00020000
    s_mov_b32 s30, 0x100
    s_mov_b32 s31, 0x00020000
    s_mov_b32 s18, 0x1000000
    s_mov_b32 s19, 0x00020000
    s_and_b32 s36, s2, 1
    s_lshl_b32 s36, s36, 3
    s_lshr_b32 s37, s2, 3
    s_and_b32 s32, s37, 7
    s_add_u32 s32, s32, s36
    s_lshr_b32 s36, s2, 1
    s_and_b32 s36, s36, 3
    s_lshl_b32 s36, s36, 2
    s_lshr_b32 s33, s37, 3
    s_add_u32 s33, s33, s36
    s_waitcnt lgkmcnt(0)
    s_add_u32 s36, s2, s3
    s_cmp_lg_u32 s36, 0
    s_cbranch_scc1 L_nononce_1
    s_memrealtime s[36:37]
    v_mov_b32 v2, 0
    s_waitcnt lgkmcnt(0)
    s_or_b32 s36, s36, 1
    v_mov_b32 v3, s36
    buffer_store_dword v3, v2, s[28:31], 0 offen sc1
L_nononce_1:
    s_and_b32 s46, s3, 3
    s_cmp_ge_u32 s3, 4
    s_cbranch_scc1 L_P1_vwave_2
    v_lshrrev_b32 v10, 3, v0
    s_lshl_b32 s36, s33, 7
    s_lshl_b32 s37, s3, 5
    s_add_u32 s36, s36, s37
    v_add_u32 v10, s36, v10
    v_lshlrev_b32 v10, 10, v10
    v_lshrrev_b32 v11, 4, v0
    v_and_b32 v12, 7, v0
    v_xor_b32 v11, v11, v12
    v_lshl_add_u32 v2, v11, 4, v10
    v_xor_b32 v3, 64, v2
    v_add_u32 v3, 7168, v3
    s_lshl_b32 s45, s3, 12
    s_mov_b32 s43, 0
    s_mov_b32 s42, 0
    s_mov_b32 s40, 0
    s_mov_b32 s41, 0
    s_add_u32 m0, s45, s42
    s_nop 0
    buffer_load_dwordx4 v2, s[8:11], s43 offen lds
    buffer_load_dwordx4 v3, s[8:11], s43 offen offset:1024 lds
    s_add_u32 s36, s45, s42
    s_add_u32 m0, s36, 2048
    s_add_u32 s37, s43, 16384
    buffer_load_dwordx4 v2, s[8:11], s37 offen lds
    buffer_load_dwordx4 v3, s[8:11], s37 offen offset:1024 lds
    s_add_u32 s43, s43, 128
    s_add_u32 s42, s42, 16384
    s_cmp_eq_u32 s42, 49152
    s_cselect_b32 s42, 0, s42
    s_add_u32 m0, s45, s42
    s_nop 0
    buffer_load_dwordx4 v2, s[8:11], s43 offen lds
    buffer_load_dwordx4 v3, s[8:11], s43 offen offset:1024 lds
    s_add_u32 s36, s45, s42
    s_add_u32 m0, s36, 2048
    s_add_u32 s37, s43, 16384
    buffer_load_dwordx4 v2, s[8:11], s37 offen lds
    buffer_load_dwordx4 v3, s[8:11], s37 offen offset:1024 lds
    s_add_u32 s43, s43, 128
    s_add_u32 s42, s42, 16384
    s_cmp_eq_u32 s42, 49152
    s_cselect_b32 s42, 0, s42
    s_add_u32 m0, s45, s42
    s_nop 0
    buffer_load_dwordx4 v2, s[8:11], s43 offen lds
    buffer_load_dwordx4 v3, s[8:11], s43 offen offset:1024 lds
    s_add_u32 s36, s45, s42
    s_add_u32 m0, s36, 2048
    s_add_u32 s37, s43, 16384
    buffer_load_dwordx4 v2, s[8:11], s37 offen lds
    buffer_load_dwordx4 v3, s[8:11], s37 offen offset:1024 lds
    s_add_u32 s43, s43, 128
    s_add_u32 s42, s42, 16384
    s_cmp_eq_u32 s42, 49152
    s_cselect_b32 s42, 0, s42
    v_and_b32 v10, 31, v0
    v_lshrrev_b32 v11, 5, v0
    v_bfe_u32 v12, v0, 1, 3
    v_xor_b32 v12, v12, v11
    v_lshlrev_b32 v12, 4, v12
    v_lshl_add_u32 v12, v10, 7, v12
    s_lshl_b32 s36, s46, 12
    v_add_u32 v4, s36, v12
    v_xor_b32 v5, 32, v4
    v_xor_b32 v6, 64, v4
    v_xor_b32 v7, 96, v4
    v_bfe_u32 v10, v0, 2, 2
    v_lshl_add_u32 v10, v11, 3, v10
    v_lshlrev_b32 v10, 6, v10
    v_bfe_u32 v12, v0, 4, 1
    v_lshl_add_u32 v10, v12, 5, v10
    v_and_b32 v12, 3, v0
    v_lshl_add_u32 v10, v12, 3, v10
    v_add_u32 v8, 49152, v10
    v_mov_b32 v64, 0
    v_mov_b32 v80, 0
    v_mov_b32 v65, 0
    v_mov_b32 v81, 0
    v_mov_b32 v66, 0
    v_mov_b32 v82, 0
    v_mov_b32 v67, 0
    v_mov_b32 v83, 0
    v_mov_b32 v68, 0
    v_mov_b32 v84, 0
    v_mov_b32 v69, 0
    v_mov_b32 v85, 0
    v_mov_b32 v70, 0
    v_mov_b32 v86, 0
    v_mov_b32 v71, 0
    v_mov_b32 v87, 0
    v_mov_b32 v72, 0
    v_mov_b32 v88, 0
    v_mov_b32 v73, 0
    v_mov_b32 v89, 0
    v_mov_b32 v74, 0
    v_mov_b32 v90, 0
    v_mov_b32 v75, 0
    v_mov_b32 v91, 0
    v_mov_b32 v76, 0
    v_mov_b32 v92, 0
    v_mov_b32 v77, 0
    v_mov_b32 v93, 0
    v_mov_b32 v78, 0
    v_mov_b32 v94, 0
    v_mov_b32 v79, 0
    v_mov_b32 v95, 0
    s_waitcnt vmcnt(8)
    s_barrier
    v_add_u32 v9, s40, v4
    v_add_u32 v13, s40, v5
    v_add_u32 v14, s41, v8
    ds_read_b128 v[16:19], v9
    ds_read_b64_tr_b16 v[24:25], v14 offset:0
    ds_read_b64_tr_b16 v[26:27], v14 offset:256
    ds_read_b64_tr_b16 v[32:33], v14 offset:2048
    ds_read_b64_tr_b16 v[34:35], v14 offset:2304
    ds_read_b128 v[20:23], v13
    ds_read_b64_tr_b16 v[28:29], v14 offset:1024
    ds_read_b64_tr_b16 v[30:31], v14 offset:1280
    ds_read_b64_tr_b16 v[36:37], v14 offset:3072
    ds_read_b64_tr_b16 v[38:39], v14 offset:3328
    s_add_u32 s41, s41, 6144
    s_cmp_eq_u32 s41, 30720
    s_cselect_b32 s41, 0, s41
    s_waitcnt vmcnt(8) lgkmcnt(0)
    s_barrier
    v_mfma_f32_32x32x16_bf16 v[64:79], v[24:27], v[16:19], v[64:79]
    v_add_u32 v9, s40, v6
    v_add_u32 v13, s40, v7
    v_add_u32 v14, s41, v8
    ds_read_b128 v[40:43], v9
    ds_read_b64_tr_b16 v[48:49], v14 offset:0
    ds_read_b64_tr_b16 v[50:51], v14 offset:256
    ds_read_b64_tr_b16 v[56:57], v14 offset:2048
    ds_read_b64_tr_b16 v[58:59], v14 offset:2304
    v_mfma_f32_32x32x16_bf16 v[80:95], v[32:35], v[16:19], v[80:95]
    ds_read_b128 v[44:47], v13
    ds_read_b64_tr_b16 v[52:53], v14 offset:1024
    ds_read_b64_tr_b16 v[54:55], v14 offset:1280
    ds_read_b64_tr_b16 v[60:61], v14 offset:3072
    ds_read_b64_tr_b16 v[62:63], v14 offset:3328
    s_add_u32 s40, s40, 16384
    s_cmp_eq_u32 s40, 49152
    s_cselect_b32 s40, 0, s40
    s_add_u32 s41, s41, 6144
    s_cmp_eq_u32 s41, 30720
    s_cselect_b32 s41, 0, s41
    v_mfma_f32_32x32x16_bf16 v[64:79], v[28:31], v[20:23], v[64:79]
    v_mfma_f32_32x32x16_bf16 v[80:95], v[36:39], v[20:23], v[80:95]
    s_mov_b32 s44, 5
L_P1_loop_4:
    s_waitcnt vmcnt(4) lgkmcnt(0)
    s_barrier
    v_mfma_f32_32x32x16_bf16 v[64:79], v[48:51], v[40:43], v[64:79]
    v_add_u32 v9, s40, v4
    v_add_u32 v13, s40, v5
    v_add_u32 v14, s41, v8
    ds_read_b128 v[16:19], v9
    ds_read_b64_tr_b16 v[24:25], v14 offset:0
    ds_read_b64_tr_b16 v[26:27], v14 offset:256
    ds_read_b64_tr_b16 v[32:33], v14 offset:2048
    ds_read_b64_tr_b16 v[34:35], v14 offset:2304
    v_mfma_f32_32x32x16_bf16 v[80:95], v[56:59], v[40:43], v[80:95]
    ds_read_b128 v[20:23], v13
    ds_read_b64_tr_b16 v[28:29], v14 offset:1024
    ds_read_b64_tr_b16 v[30:31], v14 offset:1280
    ds_read_b64_tr_b16 v[36:37], v14 offset:3072
    ds_read_b64_tr_b16 v[38:39], v14 offset:3328
    s_add_u32 s41, s41, 6144
    s_cmp_eq_u32 s41, 30720
    s_cselect_b32 s41, 0, s41
    v_mfma_f32_32x32x16_bf16 v[64:79], v[52:55], v[44:47], v[64:79]
    s_add_u32 m0, s45, s42
    s_nop 0
    buffer_load_dwordx4 v2, s[8:11], s43 offen lds
    v_mfma_f32_32x32x16_bf16 v[80:95], v[60:63], v[44:47], v[80:95]
    buffer_load_dwordx4 v3, s[8:11], s43 offen offset:1024 lds
    s_waitcnt vmcnt(6) lgkmcnt(0)
    s_barrier
    v_mfma_f32_32x32x16_bf16 v[64:79], v[24:27], v[16:19], v[64:79]
    v_add_u32 v9, s40, v6
    v_add_u32 v13, s40, v7
    v_add_u32 v14, s41, v8
    ds_read_b128 v[40:43], v9
    ds_read_b64_tr_b16 v[48:49], v14 offset:0
    ds_read_b64_tr_b16 v[50:51], v14 offset:256
    ds_read_b64_tr_b16 v[56:57], v14 offset:2048
    ds_read_b64_tr_b16 v[58:59], v14 offset:2304
    v_mfma_f32_32x32x16_bf16 v[80:95], v[32:35], v[16:19], v[80:95]
    ds_read_b128 v[44:47], v13
    ds_read_b64_tr_b16 v[52:53], v14 offset:1024
    ds_read_b64_tr_b16 v[54:55], v14 offset:1280
    ds_read_b64_tr_b16 v[60:61], v14 offset:3072
    ds_read_b64_tr_b16 v[62:63], v14 offset:3328
    s_add_u32 s40, s40, 16384
    s_cmp_eq_u32 s40, 49152
    s_cselect_b32 s40, 0, s40
    s_add_u32 s41, s41, 6144
    s_cmp_eq_u32 s41, 30720
    s_cselect_b32 s41, 0, s41
    v_mfma_f32_32x32x16_bf16 v[64:79], v[28:31], v[20:23], v[64:79]
    s_add_u32 s36, s45, s42
    s_add_u32 m0, s36, 2048
    s_add_u32 s37, s43, 16384
    buffer_load_dwordx4 v2, s[8:11], s37 offen lds
    v_mfma_f32_32x32x16_bf16 v[80:95], v[36:39], v[20:23], v[80:95]
    buffer_load_dwordx4 v3, s[8:11], s37 offen offset:1024 lds
    s_add_u32 s43, s43, 128
    s_add_u32 s42, s42, 16384
    s_cmp_eq_u32 s42, 49152
    s_cselect_b32 s42, 0, s42
    s_sub_u32 s44, s44, 1
    s_cmp_lg_u32 s44, 0
    s_cbranch_scc1 L_P1_loop_4
    s_waitcnt vmcnt(4) lgkmcnt(0)
    s_barrier
    v_mfma_f32_32x32x16_bf16 v[64:79], v[48:51], v[40:43], v[64:79]
    v_add_u32 v9, s40, v4
    v_add_u32 v13, s40, v5
    v_add_u32 v14, s41, v8
    ds_read_b128 v[16:19], v9
    ds_read_b64_tr_b16 v[24:25], v14 offset:0
    ds_read_b64_tr_b16 v[26:27], v14 offset:256
    ds_read_b64_tr_b16 v[32:33], v14 offset:2048
    ds_read_b64_tr_b16 v[34:35], v14 offset:2304
    v_mfma_f32_32x32x16_bf16 v[80:95], v[56:59], v[40:43], v[80:95]
    ds_read_b128 v[20:23], v13
    ds_read_b64_tr_b16 v[28:29], v14 offset:1024
    ds_read_b64_tr_b16 v[30:31], v14 offset:1280
    ds_read_b64_tr_b16 v[36:37], v14 offset:3072
    ds_read_b64_tr_b16 v[38:39], v14 offset:3328
    s_add_u32 s41, s41, 6144
    s_cmp_eq_u32 s41, 30720
    s_cselect_b32 s41, 0, s41
    v_mfma_f32_32x32x16_bf16 v[64:79], v[52:55], v[44:47], v[64:79]
    v_mfma_f32_32x32x16_bf16 v[80:95], v[60:63], v[44:47], v[80:95]
    s_waitcnt vmcnt(4) lgkmcnt(0)
    s_barrier
    v_mfma_f32_32x32x16_bf16 v[64:79], v[24:27], v[16:19], v[64:79]
    v_add_u32 v9, s40, v6
    v_add_u32 v13, s40, v7
    v_add_u32 v14, s41, v8
    ds_read_b128 v[40:43], v9
    ds_read_b64_tr_b16 v[48:49], v14 offset:0
    ds_read_b64_tr_b16 v[50:51], v14 offset:256
    ds_read_b64_tr_b16 v[56:57], v14 offset:2048
    ds_read_b64_tr_b16 v[58:59], v14 offset:2304
    v_mfma_f32_32x32x16_bf16 v[80:95], v[32:35], v[16:19], v[80:95]
    ds_read_b128 v[44:47], v13
    ds_read_b64_tr_b16 v[52:53], v14 offset:1024
    ds_read_b64_tr_b16 v[54:55], v14 offset:1280
    ds_read_b64_tr_b16 v[60:61], v14 offset:3072
    ds_read_b64_tr_b16 v[62:63], v14 offset:3328
    s_add_u32 s40, s40, 16384
    s_cmp_eq_u32 s40, 49152
    s_cselect_b32 s40, 0, s40
    s_add_u32 s41, s41, 6144
    s_cmp_eq_u32 s41, 30720
    s_cselect_b32 s41, 0, s41
    v_mfma_f32_32x32x16_bf16 v[64:79], v[28:31], v[20:23], v[64:79]
    v_mfma_f32_32x32x16_bf16 v[80:95], v[36:39], v[20:23], v[80:95]
    s_waitcnt vmcnt(0) lgkmcnt(0)
    s_barrier
    v_mfma_f32_32x32x16_bf16 v[64:79], v[48:51], v[40:43], v[64:79]
    v_add_u32 v9, s40, v4
    v_add_u32 v13, s40, v5
    v_add_u32 v14, s41, v8
    ds_read_b128 v[16:19], v9
    ds_read_b64_tr_b16 v[24:25], v14 offset:0
    ds_read_b64_tr_b16 v[26:27], v14 offset:256
    ds_read_b64_tr_b16 v[32:33], v14 offset:2048
    ds_read_b64_tr_b16 v[34:35], v14 offset:2304
    v_mfma_f32_32x32x16_bf16 v[80:95], v[56:59], v[40:43], v[80:95]
    ds_read_b128 v[20:23], v13
    ds_read_b64_tr_b16 v[28:29], v14 offset:1024
    ds_read_b64_tr_b16 v[30:31], v14 offset:1280
    ds_read_b64_tr_b16 v[36:37], v14 offset:3072
    ds_read_b64_tr_b16 v[38:39], v14 offset:3328
    s_add_u32 s41, s41, 6144
    s_cmp_eq_u32 s41, 30720
    s_cselect_b32 s41, 0, s41
    v_mfma_f32_32x32x16_bf16 v[64:79], v[52:55], v[44:47], v[64:79]
    v_mfma_f32_32x32x16_bf16 v[80:95], v[60:63], v[44:47], v[80:95]
    s_waitcnt vmcnt(0) lgkmcnt(0)
    s_barrier
    v_mfma_f32_32x32x16_bf16 v[64:79], v[24:27], v[16:19], v[64:79]
    v_add_u32 v9, s40, v6
    v_add_u32 v13, s40, v7
    v_add_u32 v14, s41, v8
    ds_read_b128 v[40:43], v9
    ds_read_b64_tr_b16 v[48:49], v14 offset:0
    ds_read_b64_tr_b16 v[50:51], v14 offset:256
    ds_read_b64_tr_b16 v[56:57], v14 offset:2048
    ds_read_b64_tr_b16 v[58:59], v14 offset:2304
    v_mfma_f32_32x32x16_bf16 v[80:95], v[32:35], v[16:19], v[80:95]
    ds_read_b128 v[44:47], v13
    ds_read_b64_tr_b16 v[52:53], v14 offset:1024
    ds_read_b64_tr_b16 v[54:55], v14 offset:1280
    ds_read_b64_tr_b16 v[60:61], v14 offset:3072
    ds_read_b64_tr_b16 v[62:63], v14 offset:3328
    s_add_u32 s40, s40, 16384
    s_cmp_eq_u32 s40, 49152
    s_cselect_b32 s40, 0, s40
    s_add_u32 s41, s41, 6144
    s_cmp_eq_u32 s41, 30720
    s_cselect_b32 s41, 0, s41
    v_mfma_f32_32x32x16_bf16 v[64:79], v[28:31], v[20:23], v[64:79]
    v_mfma_f32_32x32x16_bf16 v[80:95], v[36:39], v[20:23], v[80:95]
    s_waitcnt lgkmcnt(0)
    s_barrier
    v_mfma_f32_32x32x16_bf16 v[64:79], v[48:51], v[40:43], v[64:79]
    v_mfma_f32_32x32x16_bf16 v[80:95], v[56:59], v[40:43], v[80:95]
    v_mfma_f32_32x32x16_bf16 v[64:79], v[52:55], v[44:47], v[64:79]
    v_mfma_f32_32x32x16_bf16 v[80:95], v[60:63], v[44:47], v[80:95]
    s_lshl_b32 s36, s32, 4
    s_add_u32 s36, s36, s33
    s_lshl_b32 s36, s36, 14
    s_add_u32 s36, s36, 0
    s_lshl_b32 s37, s46, 10
    v_lshlrev_b32 v24, 4, v0
    v_add_u32 v24, s37, v24
    s_mov_b32 s38, 0x3eb8aa3b
    s_nop 7
    s_nop 1
    v_cvt_pk_bf16_f32 v16, v80, v81
    v_cvt_pk_bf16_f32 v17, v82, v83
    v_cvt_pk_bf16_f32 v18, v84, v85
    v_cvt_pk_bf16_f32 v19, v86, v87
    v_cvt_pk_bf16_f32 v20, v88, v89
    v_cvt_pk_bf16_f32 v21, v90, v91
    v_cvt_pk_bf16_f32 v22, v92, v93
    v_cvt_pk_bf16_f32 v23, v94, v95
    buffer_store_dwordx4 v[16:19], v24, s[16:19], s36 offen offset:0 sc1
    v_add_u32 v25, 4096, v24
    buffer_store_dwordx4 v[20:23], v25, s[16:19], s36 offen sc1
    ds_write_b128 v24, v[16:19] offset:16384
    ds_write_b128 v24, v[20:23] offset:20480
    v_mul_f32 v64, s38, v64
    v_mul_f32 v65, s38, v65
    v_mul_f32 v66, s38, v66
    v_mul_f32 v67, s38, v67
    v_mul_f32 v68, s38, v68
    v_mul_f32 v69, s38, v69
    v_mul_f32 v70, s38, v70
    v_mul_f32 v71, s38, v71
    v_mul_f32 v72, s38, v72
    v_mul_f32 v73, s38, v73
    v_mul_f32 v74, s38, v74
    v_mul_f32 v75, s38, v75
    v_mul_f32 v76, s38, v76
    v_mul_f32 v77, s38, v77
    v_mul_f32 v78, s38, v78
    v_mul_f32 v79, s38, v79
    v_cvt_pk_bf16_f32 v28, v64, v65
    v_cvt_pk_bf16_f32 v29, v66, v67
    v_cvt_pk_bf16_f32 v30, v68, v69
    v_cvt_pk_bf16_f32 v31, v70, v71
    v_cvt_pk_bf16_f32 v32, v72, v73
    v_cvt_pk_bf16_f32 v33, v74, v75
    v_cvt_pk_bf16_f32 v34, v76, v77
    v_cvt_pk_bf16_f32 v35, v78, v79
    v_add_u32 v25, 69632, v24
    ds_write_b128 v25, v[28:31] offset:0
    ds_write_b128 v25, v[32:35] offset:4096
    s_branch L_P1_join_3
L_P1_vwave_2:
    v_lshrrev_b32 v10, 2, v0
    v_mul_u32_u24 v10, 3072, v10
    v_and_b32 v12, 3, v0
    v_lshl_add_u32 v10, v12, 4, v10
    s_lshl_b32 s36, s46, 10
    s_lshl_b32 s37, s32, 6
    s_add_u32 s36, s36, s37
    v_add_u32 v2, s36, v10
    v_add_u32 v3, 48128, v2
    s_lshl_b32 s45, s46, 11
    s_add_u32 s45, s45, 49152
    s_mov_b32 s43, 0
    s_mov_b32 s42, 0
    s_mov_b32 s40, 0
    s_mov_b32 s41, 0
    s_cmp_eq_u32 s3, 7
    s_cbranch_scc1 L_P1_nodma_5
    s_add_u32 m0, s45, s42
    s_nop 0
    buffer_load_dwordx4 v2, s[12:15], s43 offen lds
    buffer_load_dwordx4 v3, s[12:15], s43 offen offset:1024 lds
L_P1_nodma_5:
    s_add_u32 s43, s43, 98304
    s_add_u32 s42, s42, 6144
    s_cmp_eq_u32 s42, 30720
    s_cselect_b32 s42, 0, s42
    s_cmp_eq_u32 s3, 7
    s_cbranch_scc1 L_P1_nodma_6
    s_add_u32 m0, s45, s42
    s_nop 0
    buffer_load_dwordx4 v2, s[12:15], s43 offen lds
    buffer_load_dwordx4 v3, s[12:15], s43 offen offset:1024 lds
L_P1_nodma_6:
    s_add_u32 s43, s43, 98304
    s_add_u32 s42, s42, 6144
    s_cmp_eq_u32 s42, 30720
    s_cselect_b32 s42, 0, s42
    s_cmp_eq_u32 s3, 7
    s_cbranch_scc1 L_P1_nodma_7
    s_add_u32 m0, s45, s42
    s_nop 0
    buffer_load_dwordx4 v2, s[12:15], s43 offen lds
    buffer_load_dwordx4 v3, s[12:15], s43 offen offset:1024 lds
L_P1_nodma_7:
    s_add_u32 s43, s43, 98304
    s_add_u32 s42, s42, 6144
    s_cmp_eq_u32 s42, 30720
    s_cselect_b32 s42, 0, s42
    s_cmp_eq_u32 s3, 7
    s_cbranch_scc1 L_P1_nodma_8
    s_add_u32 m0, s45, s42
    s_nop 0
    buffer_load_dwordx4 v2, s[12:15], s43 offen lds
    buffer_load_dwordx4 v3, s[12:15], s43 offen offset:1024 lds
L_P1_nodma_8:
    s_add_u32 s43, s43, 98304
    s_add_u32 s42, s42, 6144
    s_cmp_eq_u32 s42, 30720
    s_cselect_b32 s42, 0, s42
    s_cmp_eq_u32 s3, 7
    s_cbranch_scc1 L_P1_nodma_9
    s_add_u32 m0, s45, s42
    s_nop 0
    buffer_load_dwordx4 v2, s[12:15], s43 offen lds
    buffer_load_dwordx4 v3, s[12:15], s43 offen offset:1024 lds
L_P1_nodma_9:
    s_add_u32 s43, s43, 98304
    s_add_u32 s42, s42, 6144
    s_cmp_eq_u32 s42, 30720
    s_cselect_b32 s42, 0, s42
    v_and_b32 v10, 31, v0
    v_lshrrev_b32 v11, 5, v0
    v_bfe_u32 v12, v0, 1, 3
    v_xor_b32 v12, v12, v11
    v_lshlrev_b32 v12, 4, v12
    v_lshl_add_u32 v12, v10, 7, v12
    s_lshl_b32 s36, s46, 12
    v_add_u32 v4, s36, v12
    v_xor_b32 v5, 32, v4
    v_xor_b32 v6, 64, v4
    v_xor_b32 v7, 96, v4
    v_bfe_u32 v10, v0, 2, 2
    v_lshl_add_u32 v10, v11, 3, v10
    v_lshlrev_b32 v10, 6, v10
    v_bfe_u32 v12, v0, 4, 1
    v_lshl_add_u32 v10, v12, 5, v10
    v_and_b32 v12, 3, v0
    v_lshl_add_u32 v10, v12, 3, v10
    v_add_u32 v8, 49152, v10
    v_mov_b32 v64, 0
    v_mov_b32 v65, 0
    v_mov_b32 v66, 0
    v_mov_b32 v67, 0
    v_mov_b32 v68, 0
    v_mov_b32 v69, 0
    v_mov_b32 v70, 0
    v_mov_b32 v71, 0
    v_mov_b32 v72, 0
    v_mov_b32 v73, 0
    v_mov_b32 v74, 0
    v_mov_b32 v75, 0
    v_mov_b32 v76, 0
    v_mov_b32 v77, 0
    v_mov_b32 v78, 0
    v_mov_b32 v79, 0
    s_waitcnt vmcnt(8)
    s_barrier
    v_add_u32 v9, s40, v4
    v_add_u32 v13, s40, v5
    v_add_u32 v14, s41, v8
    ds_read_b128 v[16:19], v9
    ds_read_b64_tr_b16 v[24:25], v14 offset:4096
    ds_read_b64_tr_b16 v[26:27], v14 offset:4352
    ds_read_b128 v[20:23], v13
    ds_read_b64_tr_b16 v[28:29], v14 offset:5120
    ds_read_b64_tr_b16 v[30:31], v14 offset:5376
    s_add_u32 s41, s41, 6144
    s_cmp_eq_u32 s41, 30720
    s_cselect_b32 s41, 0, s41
    s_waitcnt vmcnt(6) lgkmcnt(0)
    s_barrier
    v_mfma_f32_32x32x16_bf16 v[64:79], v[16:19], v[24:27], v[64:79]
    v_add_u32 v9, s40, v6
    v_add_u32 v13, s40, v7
    v_add_u32 v14, s41, v8
    ds_read_b128 v[40:43], v9
    ds_read_b64_tr_b16 v[48:49], v14 offset:4096
    ds_read_b64_tr_b16 v[50:51], v14 offset:4352
    ds_read_b128 v[44:47], v13
    ds_read_b64_tr_b16 v[52:53], v14 offset:5120
    ds_read_b64_tr_b16 v[54:55], v14 offset:5376
    s_add_u32 s40, s40, 16384
    s_cmp_eq_u32 s40, 49152
    s_cselect_b32 s40, 0, s40
    s_add_u32 s41, s41, 6144
    s_cmp_eq_u32 s41, 30720
    s_cselect_b32 s41, 0, s41
    v_mfma_f32_32x32x16_bf16 v[64:79], v[20:23], v[28:31], v[64:79]
    s_cmp_eq_u32 s3, 7
    s_cbranch_scc1 L_P1_nodma_10
    s_add_u32 m0, s45, s42
    s_nop 0
    buffer_load_dwordx4 v2, s[12:15], s43 offen lds
    buffer_load_dwordx4 v3, s[12:15], s43 offen offset:1024 lds
L_P1_nodma_10:
    s_add_u32 s43, s43, 98304
    s_add_u32 s42, s42, 6144
    s_cmp_eq_u32 s42, 30720
    s_cselect_b32 s42, 0, s42
    s_mov_b32 s44, 5
L_P1_loop_11:
    s_waitcnt vmcnt(6) lgkmcnt(0)
    s_barrier
    v_mfma_f32_32x32x16_bf16 v[64:79], v[40:43], v[48:51], v[64:79]
    v_add_u32 v9, s40, v4
    v_add_u32 v13, s40, v5
    v_add_u32 v14, s41, v8
    ds_read_b128 v[16:19], v9
    ds_read_b64_tr_b16 v[24:25], v14 offset:4096
    ds_read_b64_tr_b16 v[26:27], v14 offset:4352
    ds_read_b128 v[20:23], v13
    ds_read_b64_tr_b16 v[28:29], v14 offset:5120
    ds_read_b64_tr_b16 v[30:31], v14 offset:5376
    s_add_u32 s41, s41, 6144
    s_cmp_eq_u32 s41, 30720
    s_cselect_b32 s41, 0, s41
    v_mfma_f32_32x32x16_bf16 v[64:79], v[44:47], v[52:55], v[64:79]
    s_cmp_eq_u32 s3, 7
    s_cbranch_scc1 L_P1_nodma_12
    s_add_u32 m0, s45, s42
    s_nop 0
    buffer_load_dwordx4 v2, s[12:15], s43 offen lds
    buffer_load_dwordx4 v3, s[12:15], s43 offen offset:1024 lds
L_P1_nodma_12:
    s_add_u32 s43, s43, 98304
    s_add_u32 s42, s42, 6144
    s_cmp_eq_u32 s42, 30720
    s_cselect_b32 s42, 0, s42
    s_waitcnt vmcnt(6) lgkmcnt(0)
    s_barrier
    v_mfma_f32_32x32x16_bf16 v[64:79], v[16:19], v[24:27], v[64:79]
    v_add_u32 v9, s40, v6
    v_add_u32 v13, s40, v7
    v_add_u32 v14, s41, v8
    ds_read_b128 v[40:43], v9
    ds_read_b64_tr_b16 v[48:49], v14 offset:4096
    ds_read_b64_tr_b16 v[50:51], v14 offset:4352
    ds_read_b128 v[44:47], v13
    ds_read_b64_tr_b16 v[52:53], v14 offset:5120
    ds_read_b64_tr_b16 v[54:55], v14 offset:5376
    s_add_u32 s40, s40, 16384
    s_cmp_eq_u32 s40, 49152
    s_cselect_b32 s40, 0, s40
    s_add_u32 s41, s41, 6144
    s_cmp_eq_u32 s41, 30720
    s_cselect_b32 s41, 0, s41
    v_mfma_f32_32x32x16_bf16 v[64:79], v[20:23], v[28:31], v[64:79]
    s_cmp_eq_u32 s3, 7
    s_cbranch_scc1 L_P1_nodma_13
    s_add_u32 m0, s45, s42
    s_nop 0
    buffer_load_dwordx4 v2, s[12:15], s43 offen lds
    buffer_load_dwordx4 v3, s[12:15], s43 offen offset:1024 lds
L_P1_nodma_13:
    s_add_u32 s43, s43, 98304
    s_add_u32 s42, s42, 6144
    s_cmp_eq_u32 s42, 30720
    s_cselect_b32 s42, 0, s42
    s_sub_u32 s44, s44, 1
    s_cmp_lg_u32 s44, 0
    s_cbranch_scc1 L_P1_loop_11
    s_waitcnt vmcnt(6) lgkmcnt(0)
    s_barrier
    v_mfma_f32_32x32x16_bf16 v[64:79], v[40:43], v[48:51], v[64:79]
    v_add_u32 v9, s40, v4
    v_add_u32 v13, s40, v5
    v_add_u32 v14, s41, v8
    ds_read_b128 v[16:19], v9
    ds_read_b64_tr_b16 v[24:25], v14 offset:4096
    ds_read_b64_tr_b16 v[26:27], v14 offset:4352
    ds_read_b128 v[20:23], v13
    ds_read_b64_tr_b16 v[28:29], v14 offset:5120
    ds_read_b64_tr_b16 v[30:31], v14 offset:5376
    s_add_u32 s41, s41, 6144
    s_cmp_eq_u32 s41, 30720
    s_cselect_b32 s41, 0, s41
    v_mfma_f32_32x32x16_bf16 v[64:79], v[44:47], v[52:55], v[64:79]
    s_waitcnt vmcnt(4) lgkmcnt(0)
    s_barrier
    v_mfma_f32_32x32x16_bf16 v[64:79], v[16:19], v[24:27], v[64:79]
    v_add_u32 v9, s40, v6
    v_add_u32 v13, s40, v7
    v_add_u32 v14, s41, v8
    ds_read_b128 v[40:43], v9
    ds_read_b64_tr_b16 v[48:49], v14 offset:4096
    ds_read_b64_tr_b16 v[50:51], v14 offset:4352
    ds_read_b128 v[44:47], v13
    ds_read_b64_tr_b16 v[52:53], v14 offset:5120
    ds_read_b64_tr_b16 v[54:55], v14 offset:5376
    s_add_u32 s40, s40, 16384
    s_cmp_eq_u32 s40, 49152
    s_cselect_b32 s40, 0, s40
    s_add_u32 s41, s41, 6144
    s_cmp_eq_u32 s41, 30720
    s_cselect_b32 s41, 0, s41
    v_mfma_f32_32x32x16_bf16 v[64:79], v[20:23], v[28:31], v[64:79]
    s_waitcnt vmcnt(2) lgkmcnt(0)
    s_barrier
    v_mfma_f32_32x32x16_bf16 v[64:79], v[40:43], v[48:51], v[64:79]
    v_add_u32 v9, s40, v4
    v_add_u32 v13, s40, v5
    v_add_u32 v14, s41, v8
    ds_read_b128 v[16:19], v9
    ds_read_b64_tr_b16 v[24:25], v14 offset:4096
    ds_read_b64_tr_b16 v[26:27], v14 offset:4352
    ds_read_b128 v[20:23], v13
    ds_read_b64_tr_b16 v[28:29], v14 offset:5120
    ds_read_b64_tr_b16 v[30:31], v14 offset:5376
    s_add_u32 s41, s41, 6144
    s_cmp_eq_u32 s41, 30720
    s_cselect_b32 s41, 0, s41
    v_mfma_f32_32x32x16_bf16 v[64:79], v[44:47], v[52:55], v[64:79]
    s_waitcnt vmcnt(0) lgkmcnt(0)
    s_barrier
    v_mfma_f32_32x32x16_bf16 v[64:79], v[16:19], v[24:27], v[64:79]
    v_add_u32 v9, s40, v6
    v_add_u32 v13, s40, v7
    v_add_u32 v14, s41, v8
    ds_read_b128 v[40:43], v9
    ds_read_b64_tr_b16 v[48:49], v14 offset:4096
    ds_read_b64_tr_b16 v[50:51], v14 offset:4352
    ds_read_b128 v[44:47], v13
    ds_read_b64_tr_b16 v[52:53], v14 offset:5120
    ds_read_b64_tr_b16 v[54:55], v14 offset:5376
    s_add_u32 s40, s40, 16384
    s_cmp_eq_u32 s40, 49152
    s_cselect_b32 s40, 0, s40
    s_add_u32 s41, s41, 6144
    s_cmp_eq_u32 s41, 30720
    s_cselect_b32 s41, 0, s41
    v_mfma_f32_32x32x16_bf16 v[64:79], v[20:23], v[28:31], v[64:79]
    s_waitcnt lgkmcnt(0)
    s_barrier
    v_mfma_f32_32x32x16_bf16 v[64:79], v[40:43], v[48:51], v[64:79]
    v_mfma_f32_32x32x16_bf16 v[64:79], v[44:47], v[52:55], v[64:79]
    s_lshl_b32 s36, s32, 4
    s_add_u32 s36, s36, s33
    s_lshl_b32 s36, s36, 14
    s_add_u32 s36, s36, 0
    v_bfe_u32 v10, v0, 4, 1
    v_lshlrev_b32 v10, 12, v10
    v_lshrrev_b32 v11, 5, v0
    v_lshl_add_u32 v10, v11, 8, v10
    v_and_b32 v11, 15, v0
    v_lshl_add_u32 v10, v11, 4, v10
    s_lshl_b32 s37, s46, 10
    s_add_u32 s37, s37, 8192
    v_add_u32 v24, s37, v10
    s_nop 7
    v_cvt_pk_bf16_f32 v16, v64, v65
    v_cvt_pk_bf16_f32 v17, v66, v67
    v_cvt_pk_bf16_f32 v18, v68, v69
    v_cvt_pk_bf16_f32 v19, v70, v71
    v_cvt_pk_bf16_f32 v20, v72, v73
    v_cvt_pk_bf16_f32 v21, v74, v75
    v_cvt_pk_bf16_f32 v22, v76, v77
    v_cvt_pk_bf16_f32 v23, v78, v79
    buffer_store_dwordx4 v[16:19], v24, s[16:19], s36 offen offset:0 sc1
    buffer_store_dwordx4 v[20:23], v24, s[16:19], s36 offen offset:512 sc1
    ds_write_b128 v24, v[16:19] offset:16384
    ds_write_b128 v24, v[20:23] offset:16896
    v_and_b32 v10, 31, v0
    v_cmp_eq_u32 vcc, 1, v10
    v_mov_b32 v28, 0
    v_mov_b32 v29, 0x3f803f80
    v_cndmask_b32 v28, v28, v29, vcc
    v_lshlrev_b32 v10, 4, v0
    v_mov_b32 v29, v28
    v_mov_b32 v30, v28
    v_mov_b32 v31, v28
    s_lshl_b32 s37, s46, 10
    s_add_u32 s37, s37, 65536
    v_add_u32 v10, s37, v10
    ds_write_b128 v10, v[28:31]
L_P1_join_3:
    v_mov_b32 v119, 0
    buffer_load_dword v122, v119, s[28:31], 0 offen sc1
    s_waitcnt vmcnt(0) lgkmcnt(0)
    s_barrier
    s_cmp_lg_u32 s3, 0
    s_cbranch_scc1 L_F1_notw0_14
    v_readfirstlane_b32 s34, v122
    s_nop 0
    s_cmp_lg_u32 s34, 0
    s_cbranch_scc1 L_F1_havenonce_15
    v_mov_b32 v116, 0
    s_mov_b32 s35, 400000
L_nonce_A_16:
    buffer_load_dword v117, v116, s[28:31], 0 offen sc1
    s_waitcnt vmcnt(0)
    v_readfirstlane_b32 s34, v117
    s_cmp_lg_u32 s34, 0
    s_cbranch_scc1 L_nonced_A_17
    s_sub_u32 s35, s35, 1
    s_cmp_lg_u32 s35, 0
    s_cbranch_scc1 L_nonce_A_16
L_nonced_A_17:
L_F1_havenonce_15:
    s_lshl_b32 s36, s32, 4
    s_add_u32 s37, s36, s33
    s_lshl_b32 s37, s37, 7
    s_add_u32 s37, s37, 12582912
    v_mov_b32 v116, s37
    v_mov_b32 v117, s34
    s_mov_b64 exec, 1
    buffer_store_dword v117, v116, s[16:19], 0 offen sc1
    s_mov_b64 exec, -1
L_F1_notw0_14:
    s_lshr_b32 s37, s3, 2
    v_lshlrev_b32 v116, 4, v0
    s_lshl_b32 s36, s3, 10
    s_add_u32 s36, s36, 69632
    v_add_u32 v124, s36, v116
    s_lshl_b32 s36, s37, 12
    v_add_u32 v110, s36, v116
    s_lshl_b32 s62, s3, 11
    v_add_u32 v115, s62, v116
    v_and_b32 v117, 31, v0
    v_lshrrev_b32 v118, 5, v0
    v_lshlrev_b32 v118, 8, v118
    v_lshl_add_u32 v118, v117, 4, v118
    s_add_u32 s36, s36, 8192
    v_add_u32 v118, s36, v118
    v_subrev_u32 v119, 20, v117
    v_cmp_gt_u32 vcc, 8, v119
    v_mov_b32 v119, 65536
    v_mov_b32 v111, 65600
    v_cndmask_b32 v119, v119, v111, vcc
    v_cmp_eq_u32 vcc, 16, v117
    v_mov_b32 v111, 65552
    s_nop 0
    v_cndmask_b32 v119, v119, v111, vcc
    v_cmp_gt_u32 vcc, 16, v117
    v_add_u32 v111, 0, v118
    v_add_u32 v112, 16384, v118
    v_add_u32 v113, 32768, v118
    v_add_u32 v114, 49152, v118
    v_cndmask_b32 v111, v119, v111, vcc
    v_cndmask_b32 v112, v119, v112, vcc
    v_cndmask_b32 v113, v119, v113, vcc
    v_cndmask_b32 v114, v119, v114, vcc
    v_lshrrev_b32 v117, 2, v0
    s_and_b32 s36, s3, 3
    s_lshl_b32 s36, s36, 5
    v_add_u32 v117, s36, v117
    v_lshlrev_b32 v117, 10, v117
    v_and_b32 v118, 3, v0
    v_lshl_add_u32 v117, v118, 4, v117
    s_and_b32 s36, s32, 7
    s_lshl_b32 s36, s36, 7
    s_lshl_b32 s38, s37, 6
    s_add_u32 s36, s36, s38
    v_add_u32 v120, s36, v117
    v_add_u32 v121, 15360, v120
    s_mov_b32 s63, 0
    s_lshl_b32 s57, s32, 18
    s_add_u32 s57, s57, 0
    s_add_u32 s53, s33, 1
    s_and_b32 s53, s53, 15
    ds_read_b128 v[2:5], v124
    ds_read_b128 v[86:89], v110 offset:16384
    s_waitcnt lgkmcnt(0)
    v_mfma_f32_32x32x16_bf16 v[22:37], v[86:89], v[2:5], 0
    s_nop 7
    s_nop 3
    v_max3_f32 v116, v22, v23, v24
    v_max3_f32 v116, v116, v25, v26
    v_max3_f32 v116, v116, v27, v28
    v_max3_f32 v116, v116, v29, v30
    v_max3_f32 v116, v116, v31, v32
    v_max3_f32 v116, v116, v33, v34
    v_max3_f32 v116, v116, v35, v36
    v_max_f32 v116, v116, v37
    v_mov_b32 v117, v116
    s_nop 1
    v_permlane32_swap_b32 v116, v117
    s_nop 1
    v_max_f32 v116, v116, v117
    v_sub_f32 v6, 0, v116
    v_sub_f32 v7, 0, v116
    v_sub_f32 v8, 0, v116
    v_sub_f32 v9, 0, v116
    v_sub_f32 v10, 0, v116
    v_sub_f32 v11, 0, v116
    v_sub_f32 v12, 0, v116
    v_sub_f32 v13, 0, v116
    v_sub_f32 v14, 0, v116
    v_sub_f32 v15, 0, v116
    v_sub_f32 v16, 0, v116
    v_sub_f32 v17, 0, v116
    v_sub_f32 v18, 0, v116
    v_sub_f32 v19, 0, v116
    v_sub_f32 v20, 0, v116
    v_sub_f32 v21, 0, v116
    ds_read_b128 v[94:97], v112
    ds_read_b128 v[98:101], v112 offset:512
    ds_read_b128 v[90:93], v110 offset:17408
    v_mov_b32 v70, 0
    v_mov_b32 v71, 0
    v_mov_b32 v72, 0
    v_mov_b32 v73, 0
    v_mov_b32 v74, 0
    v_mov_b32 v75, 0
    v_mov_b32 v76, 0
    v_mov_b32 v77, 0
    v_mov_b32 v78, 0
    v_mov_b32 v79, 0
    v_mov_b32 v80, 0
    v_mov_b32 v81, 0
    v_mov_b32 v82, 0
    v_mov_b32 v83, 0
    v_mov_b32 v84, 0
    v_mov_b32 v85, 0
    s_mov_b32 s60, 0x0000ffff
    s_mov_b32 s61, 0x0000ffff
    ds_read_b128 v[102:105], v112
    ds_read_b128 v[106:109], v112 offset:512
    s_waitcnt lgkmcnt(0)
    s_mov_b64 exec, s[60:61]
    v_mov_b32 v106, 0
    v_mov_b32 v107, 0
    v_mov_b32 v108, 0
    v_mov_b32 v109, 0
    s_mov_b64 exec, -1
    ds_read_b128 v[94:97], v112
    ds_read_b128 v[98:101], v112 offset:512
    ds_read_b128 v[90:93], v110 offset:17408
    v_mov_b32 v66, 0
    v_mov_b32 v67, 0
    v_mov_b32 v68, 0
    v_mov_b32 v52, 0
    v_mov_b32 v53, 0
    s_nop 1
    v_mfma_f32_32x32x16_bf16 v[22:37], v[86:89], v[2:5], v[6:21]
    s_nop 7
    s_nop 3
    s_mov_b32 s48, s16
    s_mov_b32 s49, s17
    s_mov_b32 s50, s18
    s_mov_b32 s51, s19
    v_mov_b32 v123, v115
    v_exp_f32 v22, v22
    v_exp_f32 v23, v23
    v_cvt_pk_bf16_f32 v69, v52, v53
    v_exp_f32 v24, v24
    v_exp_f32 v25, v25
    v_cvt_pk_bf16_f32 v54, v22, v23
    v_mfma_f32_32x32x16_bf16 v[70:85], v[106:109], v[66:69], v[70:85]
    s_mov_b64 exec, s[60:61]
    ds_read_b128 v[102:105], v112 offset:1024
    ds_read_b128 v[106:109], v112 offset:1536
    s_mov_b64 exec, -1
    v_exp_f32 v26, v26
    v_exp_f32 v27, v27
    v_cvt_pk_bf16_f32 v55, v24, v25
    v_exp_f32 v28, v28
    v_exp_f32 v29, v29
    v_cvt_pk_bf16_f32 v56, v26, v27
    s_waitcnt lgkmcnt(2)
    v_mfma_f32_32x32x16_bf16 v[38:53], v[90:93], v[2:5], v[6:21]
    ds_read_b128 v[86:89], v110 offset:18432
    v_exp_f32 v30, v30
    v_exp_f32 v31, v31
    v_cvt_pk_bf16_f32 v57, v28, v29
    v_exp_f32 v32, v32
    v_exp_f32 v33, v33
    v_cvt_pk_bf16_f32 v58, v30, v31
    v_exp_f32 v34, v34
    v_exp_f32 v35, v35
    v_cvt_pk_bf16_f32 v59, v32, v33
    v_mfma_f32_32x32x16_bf16 v[70:85], v[94:97], v[54:57], v[70:85]
    v_exp_f32 v36, v36
    v_exp_f32 v37, v37
    v_cvt_pk_bf16_f32 v60, v34, v35
    v_exp_f32 v38, v38
    v_exp_f32 v39, v39
    v_cvt_pk_bf16_f32 v61, v36, v37
    v_exp_f32 v40, v40
    v_exp_f32 v41, v41
    v_cvt_pk_bf16_f32 v62, v38, v39
    v_mfma_f32_32x32x16_bf16 v[70:85], v[98:101], v[58:61], v[70:85]
    s_mov_b64 exec, s[60:61]
    ds_read_b128 v[94:97], v112 offset:2048
    ds_read_b128 v[98:101], v112 offset:2560
    s_mov_b64 exec, -1
    v_exp_f32 v42, v42
    v_exp_f32 v43, v43
    v_cvt_pk_bf16_f32 v63, v40, v41
    v_exp_f32 v44, v44
    v_exp_f32 v45, v45
    v_cvt_pk_bf16_f32 v64, v42, v43
    s_waitcnt lgkmcnt(2)
    v_mfma_f32_32x32x16_bf16 v[22:37], v[86:89], v[2:5], v[6:21]
    ds_read_b128 v[90:93], v110 offset:19456
    v_exp_f32 v46, v46
    v_exp_f32 v47, v47
    v_cvt_pk_bf16_f32 v65, v44, v45
    v_exp_f32 v48, v48
    v_exp_f32 v49, v49
    v_cvt_pk_bf16_f32 v66, v46, v47
    v_exp_f32 v50, v50
    v_exp_f32 v51, v51
    v_cvt_pk_bf16_f32 v67, v48, v49
    v_mfma_f32_32x32x16_bf16 v[70:85], v[102:105], v[62:65], v[70:85]
    v_exp_f32 v52, v52
    v_exp_f32 v53, v53
    v_cvt_pk_bf16_f32 v68, v50, v51
    s_cmp_lg_u32 s3, 0
    s_cbranch_scc1 L_M0_notw0_18
    s_lshl_b32 s36, s32, 11
    s_add_u32 s36, s36, 12582912
    v_and_b32 v116, 15, v0
    v_lshlrev_b32 v116, 7, v116
    v_add_u32 v116, s36, v116
    s_mov_b32 s35, 400000
L_poll_F1_19:
    buffer_load_dword v117, v116, s[16:19], 0 offen sc1
    s_waitcnt vmcnt(0)
    v_cmp_ne_u32 vcc, s34, v117
    s_nop 4
    s_cbranch_vccz L_polld_F1_20
    s_sub_u32 s35, s35, 1
    s_cmp_lg_u32 s35, 0
    s_cbranch_scc1 L_poll_F1_19
L_polld_F1_20:
L_M0_notw0_18:
    s_barrier
    s_lshl_b32 s36, s53, 14
    s_add_u32 s36, s36, s57
    s_add_u32 m0, s62, 32768
    s_add_u32 s53, s53, 1
    s_and_b32 s53, s53, 15
    buffer_load_dwordx4 v115, s[16:19], s36 offen sc1 lds
    buffer_load_dwordx4 v115, s[16:19], s36 offen offset:1024 sc1 lds
    s_lshl_b32 s36, s53, 14
    s_add_u32 s36, s36, s57
    s_add_u32 m0, s62, 49152
    s_add_u32 s53, s53, 1
    s_and_b32 s53, s53, 15
    buffer_load_dwordx4 v115, s[16:19], s36 offen sc1 lds
    buffer_load_dwordx4 v115, s[16:19], s36 offen offset:1024 sc1 lds
    s_lshl_b32 s36, s53, 14
    s_add_u32 s36, s36, s57
    s_add_u32 m0, s62, 0
    s_add_u32 s53, s53, 1
    s_and_b32 s53, s53, 15
    buffer_load_dwordx4 v115, s[16:19], s36 offen sc1 lds
    buffer_load_dwordx4 v115, s[16:19], s36 offen offset:1024 sc1 lds
    v_exp_f32 v22, v22
    v_exp_f32 v23, v23
    v_cvt_pk_bf16_f32 v69, v52, v53
    v_exp_f32 v24, v24
    v_exp_f32 v25, v25
    v_cvt_pk_bf16_f32 v54, v22, v23
    v_mfma_f32_32x32x16_bf16 v[70:85], v[106:109], v[66:69], v[70:85]
    s_mov_b64 exec, s[60:61]
    ds_read_b128 v[102:105], v112 offset:3072
    ds_read_b128 v[106:109], v112 offset:3584
    s_mov_b64 exec, -1
    v_exp_f32 v26, v26
    v_exp_f32 v27, v27
    v_cvt_pk_bf16_f32 v55, v24, v25
    v_exp_f32 v28, v28
    v_exp_f32 v29, v29
    v_cvt_pk_bf16_f32 v56, v26, v27
    s_waitcnt lgkmcnt(2)
    v_mfma_f32_32x32x16_bf16 v[38:53], v[90:93], v[2:5], v[6:21]
    v_exp_f32 v30, v30
    v_exp_f32 v31, v31
    v_cvt_pk_bf16_f32 v57, v28, v29
    v_exp_f32 v32, v32
    v_exp_f32 v33, v33
    v_cvt_pk_bf16_f32 v58, v30, v31
    v_exp_f32 v34, v34
    v_exp_f32 v35, v35
    v_cvt_pk_bf16_f32 v59, v32, v33
    v_mfma_f32_32x32x16_bf16 v[70:85], v[94:97], v[54:57], v[70:85]
    v_exp_f32 v36, v36
    v_exp_f32 v37, v37
    v_cvt_pk_bf16_f32 v60, v34, v35
    v_exp_f32 v38, v38
    v_exp_f32 v39, v39
    v_cvt_pk_bf16_f32 v61, v36, v37
    v_exp_f32 v40, v40
    v_exp_f32 v41, v41
    v_cvt_pk_bf16_f32 v62, v38, v39
    v_mfma_f32_32x32x16_bf16 v[70:85], v[98:101], v[58:61], v[70:85]
    v_exp_f32 v42, v42
    v_exp_f32 v43, v43
    v_cvt_pk_bf16_f32 v63, v40, v41
    v_exp_f32 v44, v44
    v_exp_f32 v45, v45
    v_cvt_pk_bf16_f32 v64, v42, v43
    s_waitcnt lgkmcnt(0)
    v_exp_f32 v46, v46
    v_exp_f32 v47, v47
    v_cvt_pk_bf16_f32 v65, v44, v45
    v_exp_f32 v48, v48
    v_exp_f32 v49, v49
    v_cvt_pk_bf16_f32 v66, v46, v47
    v_exp_f32 v50, v50
    v_exp_f32 v51, v51
    v_cvt_pk_bf16_f32 v67, v48, v49
    v_mfma_f32_32x32x16_bf16 v[70:85], v[102:105], v[62:65], v[70:85]
    v_exp_f32 v52, v52
    v_exp_f32 v53, v53
    v_cvt_pk_bf16_f32 v68, v50, v51
    s_waitcnt vmcnt(4)
    s_barrier
    s_cmp_lg_u32 s3, 0
    s_cbranch_scc1 L_F6_notw0_21
    s_lshl_b32 s37, s2, 7
    s_add_u32 s37, s37, 12746752
    v_mov_b32 v116, s37
    v_mov_b32 v117, s34
    s_mov_b64 exec, 1
    buffer_store_dword v117, v116, s[16:19], 0 offen sc1
    s_mov_b64 exec, -1
L_F6_notw0_21:
    ds_read_b128 v[86:89], v110 offset:32768
    ds_read_b128 v[94:97], v113
    ds_read_b128 v[98:101], v113 offset:512
    ds_read_b128 v[90:93], v110 offset:33792
    s_mov_b32 s40, 0
    s_waitcnt lgkmcnt(3)
    v_mfma_f32_32x32x16_bf16 v[22:37], v[86:89], v[2:5], v[6:21]
    s_nop 7
    s_nop 3
L_attn_loop_22:
    v_exp_f32 v22, v22
    v_exp_f32 v23, v23
    v_cvt_pk_bf16_f32 v69, v52, v53
    v_exp_f32 v24, v24
    v_exp_f32 v25, v25
    v_cvt_pk_bf16_f32 v54, v22, v23
    v_mfma_f32_32x32x16_bf16 v[70:85], v[106:109], v[66:69], v[70:85]
    s_mov_b64 exec, s[60:61]
    ds_read_b128 v[102:105], v113 offset:1024
    ds_read_b128 v[106:109], v113 offset:1536
    s_mov_b64 exec, -1
    v_exp_f32 v26, v26
    v_exp_f32 v27, v27
    v_cvt_pk_bf16_f32 v55, v24, v25
    v_exp_f32 v28, v28
    v_exp_f32 v29, v29
    v_cvt_pk_bf16_f32 v56, v26, v27
    s_waitcnt lgkmcnt(2)
    v_mfma_f32_32x32x16_bf16 v[38:53], v[90:93], v[2:5], v[6:21]
    ds_read_b128 v[86:89], v110 offset:34816
    v_exp_f32 v30, v30
    v_exp_f32 v31, v31
    v_cvt_pk_bf16_f32 v57, v28, v29
    v_exp_f32 v32, v32
    v_exp_f32 v33, v33
    v_cvt_pk_bf16_f32 v58, v30, v31
    v_exp_f32 v34, v34
    v_exp_f32 v35, v35
    v_cvt_pk_bf16_f32 v59, v32, v33
    v_mfma_f32_32x32x16_bf16 v[70:85], v[94:97], v[54:57], v[70:85]
    v_exp_f32 v36, v36
    v_exp_f32 v37, v37
    v_cvt_pk_bf16_f32 v60, v34, v35
    v_exp_f32 v38, v38
    v_exp_f32 v39, v39
    v_cvt_pk_bf16_f32 v61, v36, v37
    v_exp_f32 v40, v40
    v_exp_f32 v41, v41
    v_cvt_pk_bf16_f32 v62, v38, v39
    v_mfma_f32_32x32x16_bf16 v[70:85], v[98:101], v[58:61], v[70:85]
    s_mov_b64 exec, s[60:61]
    ds_read_b128 v[94:97], v113 offset:2048
    ds_read_b128 v[98:101], v113 offset:2560
    s_mov_b64 exec, -1
    v_exp_f32 v42, v42
    v_exp_f32 v43, v43
    v_cvt_pk_bf16_f32 v63, v40, v41
    v_exp_f32 v44, v44
    v_exp_f32 v45, v45
    v_cvt_pk_bf16_f32 v64, v42, v43
    s_waitcnt lgkmcnt(2)
    v_mfma_f32_32x32x16_bf16 v[22:37], v[86:89], v[2:5], v[6:21]
    ds_read_b128 v[90:93], v110 offset:35840
    v_exp_f32 v46, v46
    v_exp_f32 v47, v47
    v_cvt_pk_bf16_f32 v65, v44, v45
    v_exp_f32 v48, v48
    v_exp_f32 v49, v49
    v_cvt_pk_bf16_f32 v66, v46, v47
    v_exp_f32 v50, v50
    v_exp_f32 v51, v51
    v_cvt_pk_bf16_f32 v67, v48, v49
    v_mfma_f32_32x32x16_bf16 v[70:85], v[102:105], v[62:65], v[70:85]
    v_exp_f32 v52, v52
    v_exp_f32 v53, v53
    v_cvt_pk_bf16_f32 v68, v50, v51
    s_waitcnt vmcnt(2)
    s_barrier
    s_cmp_eq_u32 s40, 3
    s_cbranch_scc1 L_R_wo_25
    s_lshl_b32 s52, s53, 14
    s_add_u32 s52, s52, s57
    s_add_u32 m0, s62, 16384
    s_add_u32 s53, s53, 1
    s_and_b32 s53, s53, 15
    s_branch L_R_done_24
L_R_wo_25:
    s_mov_b32 s48, s20
    s_mov_b32 s49, s21
    s_mov_b32 s50, s22
    s_mov_b32 s51, s23
    v_mov_b32 v115, v120
    v_mov_b32 v123, v121
    s_mov_b32 s52, 0
    s_add_u32 m0, s62, 16384
L_R_done_24:
    v_exp_f32 v22, v22
    v_exp_f32 v23, v23
    v_cvt_pk_bf16_f32 v69, v52, v53
    v_exp_f32 v24, v24
    v_exp_f32 v25, v25
    v_cvt_pk_bf16_f32 v54, v22, v23
    v_mfma_f32_32x32x16_bf16 v[70:85], v[106:109], v[66:69], v[70:85]
    s_mov_b64 exec, s[60:61]
    ds_read_b128 v[102:105], v113 offset:3072
    ds_read_b128 v[106:109], v113 offset:3584
    s_mov_b64 exec, -1
    buffer_load_dwordx4 v115, s[48:51], s52 offen sc1 lds
    v_exp_f32 v26, v26
    v_exp_f32 v27, v27
    v_cvt_pk_bf16_f32 v55, v24, v25
    v_exp_f32 v28, v28
    v_exp_f32 v29, v29
    v_cvt_pk_bf16_f32 v56, v26, v27
    s_waitcnt lgkmcnt(2)
    v_mfma_f32_32x32x16_bf16 v[38:53], v[90:93], v[2:5], v[6:21]
    ds_read_b128 v[86:89], v110 offset:49152
    v_exp_f32 v30, v30
    v_exp_f32 v31, v31
    v_cvt_pk_bf16_f32 v57, v28, v29
    v_exp_f32 v32, v32
    v_exp_f32 v33, v33
    v_cvt_pk_bf16_f32 v58, v30, v31
    v_exp_f32 v34, v34
    v_exp_f32 v35, v35
    v_cvt_pk_bf16_f32 v59, v32, v33
    v_mfma_f32_32x32x16_bf16 v[70:85], v[94:97], v[54:57], v[70:85]
    buffer_load_dwordx4 v123, s[48:51], s52 offen offset:1024 sc1 lds
    v_exp_f32 v36, v36
    v_exp_f32 v37, v37
    v_cvt_pk_bf16_f32 v60, v34, v35
    v_exp_f32 v38, v38
    v_exp_f32 v39, v39
    v_cvt_pk_bf16_f32 v61, v36, v37
    v_exp_f32 v40, v40
    v_exp_f32 v41, v41
    v_cvt_pk_bf16_f32 v62, v38, v39
    v_mfma_f32_32x32x16_bf16 v[70:85], v[98:101], v[58:61], v[70:85]
    s_mov_b64 exec, s[60:61]
    ds_read_b128 v[94:97], v114 offset:0
    ds_read_b128 v[98:101], v114 offset:512
    s_mov_b64 exec, -1
    v_exp_f32 v42, v42
    v_exp_f32 v43, v43
    v_cvt_pk_bf16_f32 v63, v40, v41
    v_exp_f32 v44, v44
    v_exp_f32 v45, v45
    v_cvt_pk_bf16_f32 v64, v42, v43
    s_waitcnt lgkmcnt(2)
    v_mfma_f32_32x32x16_bf16 v[22:37], v[86:89], v[2:5], v[6:21]
    ds_read_b128 v[90:93], v110 offset:50176
    v_exp_f32 v46, v46
    v_exp_f32 v47, v47
    v_cvt_pk_bf16_f32 v65, v44, v45
    v_exp_f32 v48, v48
    v_exp_f32 v49, v49
    v_cvt_pk_bf16_f32 v66, v46, v47
    v_exp_f32 v50, v50
    v_exp_f32 v51, v51
    v_cvt_pk_bf16_f32 v67, v48, v49
    v_mfma_f32_32x32x16_bf16 v[70:85], v[102:105], v[62:65], v[70:85]
    v_exp_f32 v52, v52
    v_exp_f32 v53, v53
    v_cvt_pk_bf16_f32 v68, v50, v51
    v_exp_f32 v22, v22
    v_exp_f32 v23, v23
    v_cvt_pk_bf16_f32 v69, v52, v53
    v_exp_f32 v24, v24
    v_exp_f32 v25, v25
    v_cvt_pk_bf16_f32 v54, v22, v23
    v_mfma_f32_32x32x16_bf16 v[70:85], v[106:109], v[66:69], v[70:85]
    s_mov_b64 exec, s[60:61]
    ds_read_b128 v[102:105], v114 offset:1024
    ds_read_b128 v[106:109], v114 offset:1536
    s_mov_b64 exec, -1
    v_exp_f32 v26, v26
    v_exp_f32 v27, v27
    v_cvt_pk_bf16_f32 v55, v24, v25
    v_exp_f32 v28, v28
    v_exp_f32 v29, v29
    v_cvt_pk_bf16_f32 v56, v26, v27
    s_waitcnt lgkmcnt(2)
    v_mfma_f32_32x32x16_bf16 v[38:53], v[90:93], v[2:5], v[6:21]
    ds_read_b128 v[86:89], v110 offset:51200
    v_exp_f32 v30, v30
    v_exp_f32 v31, v31
    v_cvt_pk_bf16_f32 v57, v28, v29
    v_exp_f32 v32, v32
    v_exp_f32 v33, v33
    v_cvt_pk_bf16_f32 v58, v30, v31
    v_exp_f32 v34, v34
    v_exp_f32 v35, v35
    v_cvt_pk_bf16_f32 v59, v32, v33
    v_mfma_f32_32x32x16_bf16 v[70:85], v[94:97], v[54:57], v[70:85]
    v_exp_f32 v36, v36
    v_exp_f32 v37, v37
    v_cvt_pk_bf16_f32 v60, v34, v35
    v_exp_f32 v38, v38
    v_exp_f32 v39, v39
    v_cvt_pk_bf16_f32 v61, v36, v37
    v_exp_f32 v40, v40
    v_exp_f32 v41, v41
    v_cvt_pk_bf16_f32 v62, v38, v39
    v_mfma_f32_32x32x16_bf16 v[70:85], v[98:101], v[58:61], v[70:85]
    s_mov_b64 exec, s[60:61]
    ds_read_b128 v[94:97], v114 offset:2048
    ds_read_b128 v[98:101], v114 offset:2560
    s_mov_b64 exec, -1
    v_exp_f32 v42, v42
    v_exp_f32 v43, v43
    v_cvt_pk_bf16_f32 v63, v40, v41
    v_exp_f32 v44, v44
    v_exp_f32 v45, v45
    v_cvt_pk_bf16_f32 v64, v42, v43
    s_waitcnt lgkmcnt(2)
    v_mfma_f32_32x32x16_bf16 v[22:37], v[86:89], v[2:5], v[6:21]
    ds_read_b128 v[90:93], v110 offset:52224
    v_exp_f32 v46, v46
    v_exp_f32 v47, v47
    v_cvt_pk_bf16_f32 v65, v44, v45
    v_exp_f32 v48, v48
    v_exp_f32 v49, v49
    v_cvt_pk_bf16_f32 v66, v46, v47
    v_exp_f32 v50, v50
    v_exp_f32 v51, v51
    v_cvt_pk_bf16_f32 v67, v48, v49
    v_mfma_f32_32x32x16_bf16 v[70:85], v[102:105], v[62:65], v[70:85]
    v_exp_f32 v52, v52
    v_exp_f32 v53, v53
    v_cvt_pk_bf16_f32 v68, v50, v51
    s_waitcnt vmcnt(2)
    s_barrier
    s_cmp_eq_u32 s40, 3
    s_cbranch_scc1 L_R_wo_27
    s_lshl_b32 s52, s53, 14
    s_add_u32 s52, s52, s57
    s_add_u32 m0, s62, 32768
    s_add_u32 s53, s53, 1
    s_and_b32 s53, s53, 15
    s_branch L_R_done_26
L_R_wo_27:
    s_mov_b32 s52, 131072
    s_add_u32 m0, s62, 32768
L_R_done_26:
    v_exp_f32 v22, v22
    v_exp_f32 v23, v23
    v_cvt_pk_bf16_f32 v69, v52, v53
    v_exp_f32 v24, v24
    v_exp_f32 v25, v25
    v_cvt_pk_bf16_f32 v54, v22, v23
    v_mfma_f32_32x32x16_bf16 v[70:85], v[106:109], v[66:69], v[70:85]
    s_mov_b64 exec, s[60:61]
    ds_read_b128 v[102:105], v114 offset:3072
    ds_read_b128 v[106:109], v114 offset:3584
    s_mov_b64 exec, -1
    buffer_load_dwordx4 v115, s[48:51], s52 offen sc1 lds
    v_exp_f32 v26, v26
    v_exp_f32 v27, v27
    v_cvt_pk_bf16_f32 v55, v24, v25
    v_exp_f32 v28, v28
    v_exp_f32 v29, v29
    v_cvt_pk_bf16_f32 v56, v26, v27
    s_waitcnt lgkmcnt(2)
    v_mfma_f32_32x32x16_bf16 v[38:53], v[90:93], v[2:5], v[6:21]
    ds_read_b128 v[86:89], v110 offset:0
    v_exp_f32 v30, v30
    v_exp_f32 v31, v31
    v_cvt_pk_bf16_f32 v57, v28, v29
    v_exp_f32 v32, v32
    v_exp_f32 v33, v33
    v_cvt_pk_bf16_f32 v58, v30, v31
    v_exp_f32 v34, v34
    v_exp_f32 v35, v35
    v_cvt_pk_bf16_f32 v59, v32, v33
    v_mfma_f32_32x32x16_bf16 v[70:85], v[94:97], v[54:57], v[70:85]
    buffer_load_dwordx4 v123, s[48:51], s52 offen offset:1024 sc1 lds
    v_exp_f32 v36, v36
    v_exp_f32 v37, v37
    v_cvt_pk_bf16_f32 v60, v34, v35
    v_exp_f32 v38, v38
    v_exp_f32 v39, v39
    v_cvt_pk_bf16_f32 v61, v36, v37
    v_exp_f32 v40, v40
    v_exp_f32 v41, v41
    v_cvt_pk_bf16_f32 v62, v38, v39
    v_mfma_f32_32x32x16_bf16 v[70:85], v[98:101], v[58:61], v[70:85]
    s_mov_b64 exec, s[60:61]
    ds_read_b128 v[94:97], v111 offset:0
    ds_read_b128 v[98:101], v111 offset:512
    s_mov_b64 exec, -1
    v_exp_f32 v42, v42
    v_exp_f32 v43, v43
    v_cvt_pk_bf16_f32 v63, v40, v41
    v_exp_f32 v44, v44
    v_exp_f32 v45, v45
    v_cvt_pk_bf16_f32 v64, v42, v43
    s_waitcnt lgkmcnt(2)
    v_mfma_f32_32x32x16_bf16 v[22:37], v[86:89], v[2:5], v[6:21]
    ds_read_b128 v[90:93], v110 offset:1024
    v_exp_f32 v46, v46
    v_exp_f32 v47, v47
    v_cvt_pk_bf16_f32 v65, v44, v45
    v_exp_f32 v48, v48
    v_exp_f32 v49, v49
    v_cvt_pk_bf16_f32 v66, v46, v47
    v_exp_f32 v50, v50
    v_exp_f32 v51, v51
    v_cvt_pk_bf16_f32 v67, v48, v49
    v_mfma_f32_32x32x16_bf16 v[70:85], v[102:105], v[62:65], v[70:85]
    v_exp_f32 v52, v52
    v_exp_f32 v53, v53
    v_cvt_pk_bf16_f32 v68, v50, v51
    v_exp_f32 v22, v22
    v_exp_f32 v23, v23
    v_cvt_pk_bf16_f32 v69, v52, v53
    v_exp_f32 v24, v24
    v_exp_f32 v25, v25
    v_cvt_pk_bf16_f32 v54, v22, v23
    v_mfma_f32_32x32x16_bf16 v[70:85], v[106:109], v[66:69], v[70:85]
    s_mov_b64 exec, s[60:61]
    ds_read_b128 v[102:105], v111 offset:1024
    ds_read_b128 v[106:109], v111 offset:1536
    s_mov_b64 exec, -1
    v_exp_f32 v26, v26
    v_exp_f32 v27, v27
    v_cvt_pk_bf16_f32 v55, v24, v25
    v_exp_f32 v28, v28
    v_exp_f32 v29, v29
    v_cvt_pk_bf16_f32 v56, v26, v27
    s_waitcnt lgkmcnt(2)
    v_mfma_f32_32x32x16_bf16 v[38:53], v[90:93], v[2:5], v[6:21]
    ds_read_b128 v[86:89], v110 offset:2048
    v_exp_f32 v30, v30
    v_exp_f32 v31, v31
    v_cvt_pk_bf16_f32 v57, v28, v29
    v_exp_f32 v32, v32
    v_exp_f32 v33, v33
    v_cvt_pk_bf16_f32 v58, v30, v31
    v_exp_f32 v34, v34
    v_exp_f32 v35, v35
    v_cvt_pk_bf16_f32 v59, v32, v33
    v_mfma_f32_32x32x16_bf16 v[70:85], v[94:97], v[54:57], v[70:85]
    v_exp_f32 v36, v36
    v_exp_f32 v37, v37
    v_cvt_pk_bf16_f32 v60, v34, v35
    v_exp_f32 v38, v38
    v_exp_f32 v39, v39
    v_cvt_pk_bf16_f32 v61, v36, v37
    v_exp_f32 v40, v40
    v_exp_f32 v41, v41
    v_cvt_pk_bf16_f32 v62, v38, v39
    v_mfma_f32_32x32x16_bf16 v[70:85], v[98:101], v[58:61], v[70:85]
    s_mov_b64 exec, s[60:61]
    ds_read_b128 v[94:97], v111 offset:2048
    ds_read_b128 v[98:101], v111 offset:2560
    s_mov_b64 exec, -1
    v_exp_f32 v42, v42
    v_exp_f32 v43, v43
    v_cvt_pk_bf16_f32 v63, v40, v41
    v_exp_f32 v44, v44
    v_exp_f32 v45, v45
    v_cvt_pk_bf16_f32 v64, v42, v43
    s_waitcnt lgkmcnt(2)
    v_mfma_f32_32x32x16_bf16 v[22:37], v[86:89], v[2:5], v[6:21]
    ds_read_b128 v[90:93], v110 offset:3072
    v_exp_f32 v46, v46
    v_exp_f32 v47, v47
    v_cvt_pk_bf16_f32 v65, v44, v45
    v_exp_f32 v48, v48
    v_exp_f32 v49, v49
    v_cvt_pk_bf16_f32 v66, v46, v47
    v_exp_f32 v50, v50
    v_exp_f32 v51, v51
    v_cvt_pk_bf16_f32 v67, v48, v49
    v_mfma_f32_32x32x16_bf16 v[70:85], v[102:105], v[62:65], v[70:85]
    v_exp_f32 v52, v52
    v_exp_f32 v53, v53
    v_cvt_pk_bf16_f32 v68, v50, v51
    s_waitcnt vmcnt(2)
    s_barrier
    s_cmp_eq_u32 s40, 3
    s_cbranch_scc1 L_R_wo_29
    s_lshl_b32 s52, s53, 14
    s_add_u32 s52, s52, s57
    s_add_u32 m0, s62, 49152
    s_add_u32 s53, s53, 1
    s_and_b32 s53, s53, 15
    s_branch L_R_done_28
L_R_wo_29:
    s_mov_b32 s52, 262144
    s_add_u32 m0, s62, 49152
L_R_done_28:
    v_exp_f32 v22, v22
    v_exp_f32 v23, v23
    v_cvt_pk_bf16_f32 v69, v52, v53
    v_exp_f32 v24, v24
    v_exp_f32 v25, v25
    v_cvt_pk_bf16_f32 v54, v22, v23
    v_mfma_f32_32x32x16_bf16 v[70:85], v[106:109], v[66:69], v[70:85]
    s_mov_b64 exec, s[60:61]
    ds_read_b128 v[102:105], v111 offset:3072
    ds_read_b128 v[106:109], v111 offset:3584
    s_mov_b64 exec, -1
    buffer_load_dwordx4 v115, s[48:51], s52 offen sc1 lds
    v_exp_f32 v26, v26
    v_exp_f32 v27, v27
    v_cvt_pk_bf16_f32 v55, v24, v25
    v_exp_f32 v28, v28
    v_exp_f32 v29, v29
    v_cvt_pk_bf16_f32 v56, v26, v27
    s_waitcnt lgkmcnt(2)
    v_mfma_f32_32x32x16_bf16 v[38:53], v[90:93], v[2:5], v[6:21]
    ds_read_b128 v[86:89], v110 offset:16384
    v_exp_f32 v30, v30
    v_exp_f32 v31, v31
    v_cvt_pk_bf16_f32 v57, v28, v29
    v_exp_f32 v32, v32
    v_exp_f32 v33, v33
    v_cvt_pk_bf16_f32 v58, v30, v31
    v_exp_f32 v34, v34
    v_exp_f32 v35, v35
    v_cvt_pk_bf16_f32 v59, v32, v33
    v_mfma_f32_32x32x16_bf16 v[70:85], v[94:97], v[54:57], v[70:85]
    buffer_load_dwordx4 v123, s[48:51], s52 offen offset:1024 sc1 lds
    v_exp_f32 v36, v36
    v_exp_f32 v37, v37
    v_cvt_pk_bf16_f32 v60, v34, v35
    v_exp_f32 v38, v38
    v_exp_f32 v39, v39
    v_cvt_pk_bf16_f32 v61, v36, v37
    v_exp_f32 v40, v40
    v_exp_f32 v41, v41
    v_cvt_pk_bf16_f32 v62, v38, v39
    v_mfma_f32_32x32x16_bf16 v[70:85], v[98:101], v[58:61], v[70:85]
    s_mov_b64 exec, s[60:61]
    ds_read_b128 v[94:97], v112 offset:0
    ds_read_b128 v[98:101], v112 offset:512
    s_mov_b64 exec, -1
    v_exp_f32 v42, v42
    v_exp_f32 v43, v43
    v_cvt_pk_bf16_f32 v63, v40, v41
    v_exp_f32 v44, v44
    v_exp_f32 v45, v45
    v_cvt_pk_bf16_f32 v64, v42, v43
    s_waitcnt lgkmcnt(2)
    v_mfma_f32_32x32x16_bf16 v[22:37], v[86:89], v[2:5], v[6:21]
    ds_read_b128 v[90:93], v110 offset:17408
    v_exp_f32 v46, v46
    v_exp_f32 v47, v47
    v_cvt_pk_bf16_f32 v65, v44, v45
    v_exp_f32 v48, v48
    v_exp_f32 v49, v49
    v_cvt_pk_bf16_f32 v66, v46, v47
    v_exp_f32 v50, v50
    v_exp_f32 v51, v51
    v_cvt_pk_bf16_f32 v67, v48, v49
    v_mfma_f32_32x32x16_bf16 v[70:85], v[102:105], v[62:65], v[70:85]
    v_exp_f32 v52, v52
    v_exp_f32 v53, v53
    v_cvt_pk_bf16_f32 v68, v50, v51
    s_cmp_eq_u32 s40, 3
    s_cbranch_scc1 L_attn_done_23
    v_exp_f32 v22, v22
    v_exp_f32 v23, v23
    v_cvt_pk_bf16_f32 v69, v52, v53
    v_exp_f32 v24, v24
    v_exp_f32 v25, v25
    v_cvt_pk_bf16_f32 v54, v22, v23
    v_mfma_f32_32x32x16_bf16 v[70:85], v[106:109], v[66:69], v[70:85]
    s_mov_b64 exec, s[60:61]
    ds_read_b128 v[102:105], v112 offset:1024
    ds_read_b128 v[106:109], v112 offset:1536
    s_mov_b64 exec, -1
    v_exp_f32 v26, v26
    v_exp_f32 v27, v27
    v_cvt_pk_bf16_f32 v55, v24, v25
    v_exp_f32 v28, v28
    v_exp_f32 v29, v29
    v_cvt_pk_bf16_f32 v56, v26, v27
    s_waitcnt lgkmcnt(2)
    v_mfma_f32_32x32x16_bf16 v[38:53], v[90:93], v[2:5], v[6:21]
    ds_read_b128 v[86:89], v110 offset:18432
    v_exp_f32 v30, v30
    v_exp_f32 v31, v31
    v_cvt_pk_bf16_f32 v57, v28, v29
    v_exp_f32 v32, v32
    v_exp_f32 v33, v33
    v_cvt_pk_bf16_f32 v58, v30, v31
    v_exp_f32 v34, v34
    v_exp_f32 v35, v35
    v_cvt_pk_bf16_f32 v59, v32, v33
    v_mfma_f32_32x32x16_bf16 v[70:85], v[94:97], v[54:57], v[70:85]
    v_exp_f32 v36, v36
    v_exp_f32 v37, v37
    v_cvt_pk_bf16_f32 v60, v34, v35
    v_exp_f32 v38, v38
    v_exp_f32 v39, v39
    v_cvt_pk_bf16_f32 v61, v36, v37
    v_exp_f32 v40, v40
    v_exp_f32 v41, v41
    v_cvt_pk_bf16_f32 v62, v38, v39
    v_mfma_f32_32x32x16_bf16 v[70:85], v[98:101], v[58:61], v[70:85]
    s_mov_b64 exec, s[60:61]
    ds_read_b128 v[94:97], v112 offset:2048
    ds_read_b128 v[98:101], v112 offset:2560
    s_mov_b64 exec, -1
    v_exp_f32 v42, v42
    v_exp_f32 v43, v43
    v_cvt_pk_bf16_f32 v63, v40, v41
    v_exp_f32 v44, v44
    v_exp_f32 v45, v45
    v_cvt_pk_bf16_f32 v64, v42, v43
    s_waitcnt lgkmcnt(2)
    v_mfma_f32_32x32x16_bf16 v[22:37], v[86:89], v[2:5], v[6:21]
    ds_read_b128 v[90:93], v110 offset:19456
    v_exp_f32 v46, v46
    v_exp_f32 v47, v47
    v_cvt_pk_bf16_f32 v65, v44, v45
    v_exp_f32 v48, v48
    v_exp_f32 v49, v49
    v_cvt_pk_bf16_f32 v66, v46, v47
    v_exp_f32 v50, v50
    v_exp_f32 v51, v51
    v_cvt_pk_bf16_f32 v67, v48, v49
    v_mfma_f32_32x32x16_bf16 v[70:85], v[102:105], v[62:65], v[70:85]
    v_exp_f32 v52, v52
    v_exp_f32 v53, v53
    v_cvt_pk_bf16_f32 v68, v50, v51
    s_waitcnt vmcnt(2)
    s_barrier
    s_lshl_b32 s52, s53, 14
    s_add_u32 s52, s52, s57
    s_add_u32 m0, s62, 0
    s_add_u32 s53, s53, 1
    s_and_b32 s53, s53, 15
    v_exp_f32 v22, v22
    v_exp_f32 v23, v23
    v_cvt_pk_bf16_f32 v69, v52, v53
    v_exp_f32 v24, v24
    v_exp_f32 v25, v25
    v_cvt_pk_bf16_f32 v54, v22, v23
    v_mfma_f32_32x32x16_bf16 v[70:85], v[106:109], v[66:69], v[70:85]
    s_mov_b64 exec, s[60:61]
    ds_read_b128 v[102:105], v112 offset:3072
    ds_read_b128 v[106:109], v112 offset:3584
    s_mov_b64 exec, -1
    buffer_load_dwordx4 v115, s[48:51], s52 offen sc1 lds
    v_exp_f32 v26, v26
    v_exp_f32 v27, v27
    v_cvt_pk_bf16_f32 v55, v24, v25
    v_exp_f32 v28, v28
    v_exp_f32 v29, v29
    v_cvt_pk_bf16_f32 v56, v26, v27
    s_waitcnt lgkmcnt(2)
    v_mfma_f32_32x32x16_bf16 v[38:53], v[90:93], v[2:5], v[6:21]
    ds_read_b128 v[86:89], v110 offset:32768
    v_exp_f32 v30, v30
    v_exp_f32 v31, v31
    v_cvt_pk_bf16_f32 v57, v28, v29
    v_exp_f32 v32, v32
    v_exp_f32 v33, v33
    v_cvt_pk_bf16_f32 v58, v30, v31
    v_exp_f32 v34, v34
    v_exp_f32 v35, v35
    v_cvt_pk_bf16_f32 v59, v32, v33
    v_mfma_f32_32x32x16_bf16 v[70:85], v[94:97], v[54:57], v[70:85]
    buffer_load_dwordx4 v123, s[48:51], s52 offen offset:1024 sc1 lds
    v_exp_f32 v36, v36
    v_exp_f32 v37, v37
    v_cvt_pk_bf16_f32 v60, v34, v35
    v_exp_f32 v38, v38
    v_exp_f32 v39, v39
    v_cvt_pk_bf16_f32 v61, v36, v37
    v_exp_f32 v40, v40
    v_exp_f32 v41, v41
    v_cvt_pk_bf16_f32 v62, v38, v39
    v_mfma_f32_32x32x16_bf16 v[70:85], v[98:101], v[58:61], v[70:85]
    s_mov_b64 exec, s[60:61]
    ds_read_b128 v[94:97], v113 offset:0
    ds_read_b128 v[98:101], v113 offset:512
    s_mov_b64 exec, -1
    v_exp_f32 v42, v42
    v_exp_f32 v43, v43
    v_cvt_pk_bf16_f32 v63, v40, v41
    v_exp_f32 v44, v44
    v_exp_f32 v45, v45
    v_cvt_pk_bf16_f32 v64, v42, v43
    s_waitcnt lgkmcnt(2)
    v_mfma_f32_32x32x16_bf16 v[22:37], v[86:89], v[2:5], v[6:21]
    ds_read_b128 v[90:93], v110 offset:33792
    v_exp_f32 v46, v46
    v_exp_f32 v47, v47
    v_cvt_pk_bf16_f32 v65, v44, v45
    v_exp_f32 v48, v48
    v_exp_f32 v49, v49
    v_cvt_pk_bf16_f32 v66, v46, v47
    v_exp_f32 v50, v50
    v_exp_f32 v51, v51
    v_cvt_pk_bf16_f32 v67, v48, v49
    v_mfma_f32_32x32x16_bf16 v[70:85], v[102:105], v[62:65], v[70:85]
    v_exp_f32 v52, v52
    v_exp_f32 v53, v53
    v_cvt_pk_bf16_f32 v68, v50, v51
    s_add_u32 s40, s40, 1
    s_branch L_attn_loop_22
L_attn_done_23:
    v_cvt_pk_bf16_f32 v69, v52, v53
    s_waitcnt lgkmcnt(0)
    s_nop 0
    v_mfma_f32_32x32x16_bf16 v[70:85], v[106:109], v[66:69], v[70:85]
    s_mov_b32 s54, 0
L_fin_30:
    s_lshl_b32 s36, s33, 2
    s_and_b32 s37, s3, 3
    s_add_u32 s36, s36, s37
    s_lshl_b32 s36, s36, 5
    s_lshl_b32 s37, s32, 1
    s_add_u32 s36, s36, s37
    s_lshr_b32 s37, s3, 2
    s_add_u32 s36, s36, s37
    s_lshl_b32 s36, s36, 10
    s_add_u32 s36, s36, 4194304
    v_lshlrev_b32 v117, 4, v0
    s_nop 7
    v_mov_b32 v116, v78
    v_mov_b32 v118, v78
    s_nop 1
    v_permlane32_swap_b32 v116, v118
    s_nop 1
    v_rcp_f32 v118, v116
    s_nop 0
    v_mul_f32 v70, v118, v70
    v_mul_f32 v71, v118, v71
    v_mul_f32 v72, v118, v72
    v_mul_f32 v73, v118, v73
    v_mul_f32 v74, v118, v74
    v_mul_f32 v75, v118, v75
    v_mul_f32 v76, v118, v76
    v_mul_f32 v77, v118, v77
    v_cvt_pk_bf16_f32 v54, v70, v71
    v_cvt_pk_bf16_f32 v55, v72, v73
    v_cvt_pk_bf16_f32 v56, v74, v75
    v_cvt_pk_bf16_f32 v57, v76, v77
    buffer_store_dwordx4 v[54:57], v117, s[16:19], s36 offen sc1
    s_mov_b32 s38, 0x5d800000
    s_movk_i32 s39, 0x207
    v_cmp_nge_f32 s[58:59], s38, v116
    s_mov_b32 s38, 0x3f000000
    v_cmp_nle_f32 vcc, s38, v116
    s_nop 0
    s_or_b64 s[58:59], s[58:59], vcc
    v_cmp_class_f32 s[60:61], v70, s39
    s_nop 0
    s_or_b64 s[58:59], s[58:59], s[60:61]
    v_cmp_class_f32 s[60:61], v71, s39
    s_nop 0
    s_or_b64 s[58:59], s[58:59], s[60:61]
    v_cmp_class_f32 s[60:61], v72, s39
    s_nop 0
    s_or_b64 s[58:59], s[58:59], s[60:61]
    v_cmp_class_f32 s[60:61], v73, s39
    s_nop 0
    s_or_b64 s[58:59], s[58:59], s[60:61]
    v_cmp_class_f32 s[60:61], v74, s39
    s_nop 0
    s_or_b64 s[58:59], s[58:59], s[60:61]
    v_cmp_class_f32 s[60:61], v75, s39
    s_nop 0
    s_or_b64 s[58:59], s[58:59], s[60:61]
    v_cmp_class_f32 s[60:61], v76, s39
    s_nop 0
    s_or_b64 s[58:59], s[58:59], s[60:61]
    v_cmp_class_f32 s[60:61], v77, s39
    s_nop 0
    s_or_b64 s[58:59], s[58:59], s[60:61]
    s_cmp_eq_u64 s[58:59], 0
    s_cbranch_scc1 L_rows_ok_31
    v_mov_b32 v118, 65792
    v_mov_b32 v119, 1
    ds_write_b32 v118, v119
L_rows_ok_31:
    s_waitcnt vmcnt(0) lgkmcnt(0)
    s_barrier
    s_cmp_lg_u32 s54, 0
    s_cbranch_scc1 L_fin_ok_32
    v_mov_b32 v118, 65792
    ds_read_b32 v119, v118
    s_waitcnt lgkmcnt(0)
    v_readfirstlane_b32 s36, v119
    s_nop 0
    s_cmp_eq_u32 s36, 0
    s_cbranch_scc1 L_fin_ok_32
    s_mov_b32 s54, 1
    s_waitcnt vmcnt(0)
    v_lshlrev_b32 v119, 4, v0
    v_add_u32 v119, s62, v119
    v_mov_b32 v116, 0xff800000
    s_mov_b32 s56, 0
L_slow_max_33:
    s_barrier
    s_lshl_b32 s36, s56, 14
    s_add_u32 s36, s36, s57
    s_mov_b32 m0, s62
    s_add_u32 s56, s56, 1
    buffer_load_dwordx4 v119, s[16:19], s36 offen sc1 lds
    buffer_load_dwordx4 v119, s[16:19], s36 offen offset:1024 sc1 lds
    s_waitcnt vmcnt(0)
    s_barrier
    ds_read_b128 v[86:89], v110 offset:0
    s_waitcnt lgkmcnt(0)
    v_mfma_f32_32x32x16_bf16 v[22:37], v[86:89], v[2:5], 0
    s_nop 7
    s_nop 3
    v_max3_f32 v116, v116, v22, v23
    v_max3_f32 v116, v116, v24, v25
    v_max3_f32 v116, v116, v26, v27
    v_max3_f32 v116, v116, v28, v29
    v_max3_f32 v116, v116, v30, v31
    v_max3_f32 v116, v116, v32, v33
    v_max3_f32 v116, v116, v34, v35
    v_max3_f32 v116, v116, v36, v37
    ds_read_b128 v[86:89], v110 offset:1024
    s_waitcnt lgkmcnt(0)
    v_mfma_f32_32x32x16_bf16 v[22:37], v[86:89], v[2:5], 0
    s_nop 7
    s_nop 3
    v_max3_f32 v116, v116, v22, v23
    v_max3_f32 v116, v116, v24, v25
    v_max3_f32 v116, v116, v26, v27
    v_max3_f32 v116, v116, v28, v29
    v_max3_f32 v116, v116, v30, v31
    v_max3_f32 v116, v116, v32, v33
    v_max3_f32 v116, v116, v34, v35
    v_max3_f32 v116, v116, v36, v37
    ds_read_b128 v[86:89], v110 offset:2048
    s_waitcnt lgkmcnt(0)
    v_mfma_f32_32x32x16_bf16 v[22:37], v[86:89], v[2:5], 0
    s_nop 7
    s_nop 3
    v_max3_f32 v116, v116, v22, v23
    v_max3_f32 v116, v116, v24, v25
    v_max3_f32 v116, v116, v26, v27
    v_max3_f32 v116, v116, v28, v29
    v_max3_f32 v116, v116, v30, v31
    v_max3_f32 v116, v116, v32, v33
    v_max3_f32 v116, v116, v34, v35
    v_max3_f32 v116, v116, v36, v37
    ds_read_b128 v[86:89], v110 offset:3072
    s_waitcnt lgkmcnt(0)
    v_mfma_f32_32x32x16_bf16 v[22:37], v[86:89], v[2:5], 0
    s_nop 7
    s_nop 3
    v_max3_f32 v116, v116, v22, v23
    v_max3_f32 v116, v116, v24, v25
    v_max3_f32 v116, v116, v26, v27
    v_max3_f32 v116, v116, v28, v29
    v_max3_f32 v116, v116, v30, v31
    v_max3_f32 v116, v116, v32, v33
    v_max3_f32 v116, v116, v34, v35
    v_max3_f32 v116, v116, v36, v37
    s_cmp_lg_u32 s56, 16
    s_cbranch_scc1 L_slow_max_33
    v_mov_b32 v117, v116
    s_nop 1
    v_permlane32_swap_b32 v116, v117
    s_nop 1
    v_max_f32 v116, v116, v117
    v_sub_f32 v6, 0, v116
    v_mov_b32 v70, 0
    v_sub_f32 v7, 0, v116
    v_mov_b32 v71, 0
    v_sub_f32 v8, 0, v116
    v_mov_b32 v72, 0
    v_sub_f32 v9, 0, v116
    v_mov_b32 v73, 0
    v_sub_f32 v10, 0, v116
    v_mov_b32 v74, 0
    v_sub_f32 v11, 0, v116
    v_mov_b32 v75, 0
    v_sub_f32 v12, 0, v116
    v_mov_b32 v76, 0
    v_sub_f32 v13, 0, v116
    v_mov_b32 v77, 0
    v_sub_f32 v14, 0, v116
    v_mov_b32 v78, 0
    v_sub_f32 v15, 0, v116
    v_mov_b32 v79, 0
    v_sub_f32 v16, 0, v116
    v_mov_b32 v80, 0
    v_sub_f32 v17, 0, v116
    v_mov_b32 v81, 0
    v_sub_f32 v18, 0, v116
    v_mov_b32 v82, 0
    v_sub_f32 v19, 0, v116
    v_mov_b32 v83, 0
    v_sub_f32 v20, 0, v116
    v_mov_b32 v84, 0
    v_sub_f32 v21, 0, v116
    v_mov_b32 v85, 0
    s_mov_b32 s56, 0
L_slow_main_34:
    s_barrier
    s_lshl_b32 s36, s56, 14
    s_add_u32 s36, s36, s57
    s_mov_b32 m0, s62
    s_add_u32 s56, s56, 1
    buffer_load_dwordx4 v119, s[16:19], s36 offen sc1 lds
    buffer_load_dwordx4 v119, s[16:19], s36 offen offset:1024 sc1 lds
    s_waitcnt vmcnt(0)
    s_barrier
    ds_read_b128 v[86:89], v110 offset:0
    ds_read_b128 v[94:97], v111 offset:0
    ds_read_b128 v[98:101], v111 offset:512
    s_waitcnt lgkmcnt(0)
    v_mfma_f32_32x32x16_bf16 v[22:37], v[86:89], v[2:5], v[6:21]
    s_nop 7
    s_nop 3
    v_exp_f32 v22, v22
    v_exp_f32 v23, v23
    v_exp_f32 v24, v24
    v_exp_f32 v25, v25
    v_exp_f32 v26, v26
    v_exp_f32 v27, v27
    v_exp_f32 v28, v28
    v_exp_f32 v29, v29
    v_exp_f32 v30, v30
    v_exp_f32 v31, v31
    v_exp_f32 v32, v32
    v_exp_f32 v33, v33
    v_exp_f32 v34, v34
    v_exp_f32 v35, v35
    v_exp_f32 v36, v36
    v_exp_f32 v37, v37
    s_nop 0
    v_cvt_pk_bf16_f32 v54, v22, v23
    v_cvt_pk_bf16_f32 v55, v24, v25
    v_cvt_pk_bf16_f32 v56, v26, v27
    v_cvt_pk_bf16_f32 v57, v28, v29
    v_cvt_pk_bf16_f32 v58, v30, v31
    v_cvt_pk_bf16_f32 v59, v32, v33
    v_cvt_pk_bf16_f32 v60, v34, v35
    v_cvt_pk_bf16_f32 v61, v36, v37
    s_nop 1
    v_mfma_f32_32x32x16_bf16 v[70:85], v[94:97], v[54:57], v[70:85]
    v_mfma_f32_32x32x16_bf16 v[70:85], v[98:101], v[58:61], v[70:85]
    ds_read_b128 v[86:89], v110 offset:1024
    ds_read_b128 v[94:97], v111 offset:1024
    ds_read_b128 v[98:101], v111 offset:1536
    s_waitcnt lgkmcnt(0)
    v_mfma_f32_32x32x16_bf16 v[22:37], v[86:89], v[2:5], v[6:21]
    s_nop 7
    s_nop 3
    v_exp_f32 v22, v22
    v_exp_f32 v23, v23
    v_exp_f32 v24, v24
    v_exp_f32 v25, v25
    v_exp_f32 v26, v26
    v_exp_f32 v27, v27
    v_exp_f32 v28, v28
    v_exp_f32 v29, v29
    v_exp_f32 v30, v30
    v_exp_f32 v31, v31
    v_exp_f32 v32, v32
    v_exp_f32 v33, v33
    v_exp_f32 v34, v34
    v_exp_f32 v35, v35
    v_exp_f32 v36, v36
    v_exp_f32 v37, v37
    s_nop 0
    v_cvt_pk_bf16_f32 v54, v22, v23
    v_cvt_pk_bf16_f32 v55, v24, v25
    v_cvt_pk_bf16_f32 v56, v26, v27
    v_cvt_pk_bf16_f32 v57, v28, v29
    v_cvt_pk_bf16_f32 v58, v30, v31
    v_cvt_pk_bf16_f32 v59, v32, v33
    v_cvt_pk_bf16_f32 v60, v34, v35
    v_cvt_pk_bf16_f32 v61, v36, v37
    s_nop 1
    v_mfma_f32_32x32x16_bf16 v[70:85], v[94:97], v[54:57], v[70:85]
    v_mfma_f32_32x32x16_bf16 v[70:85], v[98:101], v[58:61], v[70:85]
    ds_read_b128 v[86:89], v110 offset:2048
    ds_read_b128 v[94:97], v111 offset:2048
    ds_read_b128 v[98:101], v111 offset:2560
    s_waitcnt lgkmcnt(0)
    v_mfma_f32_32x32x16_bf16 v[22:37], v[86:89], v[2:5], v[6:21]
    s_nop 7
    s_nop 3
    v_exp_f32 v22, v22
    v_exp_f32 v23, v23
    v_exp_f32 v24, v24
    v_exp_f32 v25, v25
    v_exp_f32 v26, v26
    v_exp_f32 v27, v27
    v_exp_f32 v28, v28
    v_exp_f32 v29, v29
    v_exp_f32 v30, v30
    v_exp_f32 v31, v31
    v_exp_f32 v32, v32
    v_exp_f32 v33, v33
    v_exp_f32 v34, v34
    v_exp_f32 v35, v35
    v_exp_f32 v36, v36
    v_exp_f32 v37, v37
    s_nop 0
    v_cvt_pk_bf16_f32 v54, v22, v23
    v_cvt_pk_bf16_f32 v55, v24, v25
    v_cvt_pk_bf16_f32 v56, v26, v27
    v_cvt_pk_bf16_f32 v57, v28, v29
    v_cvt_pk_bf16_f32 v58, v30, v31
    v_cvt_pk_bf16_f32 v59, v32, v33
    v_cvt_pk_bf16_f32 v60, v34, v35
    v_cvt_pk_bf16_f32 v61, v36, v37
    s_nop 1
    v_mfma_f32_32x32x16_bf16 v[70:85], v[94:97], v[54:57], v[70:85]
    v_mfma_f32_32x32x16_bf16 v[70:85], v[98:101], v[58:61], v[70:85]
    ds_read_b128 v[86:89], v110 offset:3072
    ds_read_b128 v[94:97], v111 offset:3072
    ds_read_b128 v[98:101], v111 offset:3584
    s_waitcnt lgkmcnt(0)
    v_mfma_f32_32x32x16_bf16 v[22:37], v[86:89], v[2:5], v[6:21]
    s_nop 7
    s_nop 3
    v_exp_f32 v22, v22
    v_exp_f32 v23, v23
    v_exp_f32 v24, v24
    v_exp_f32 v25, v25
    v_exp_f32 v26, v26
    v_exp_f32 v27, v27
    v_exp_f32 v28, v28
    v_exp_f32 v29, v29
    v_exp_f32 v30, v30
    v_exp_f32 v31, v31
    v_exp_f32 v32, v32
    v_exp_f32 v33, v33
    v_exp_f32 v34, v34
    v_exp_f32 v35, v35
    v_exp_f32 v36, v36
    v_exp_f32 v37, v37
    s_nop 0
    v_cvt_pk_bf16_f32 v54, v22, v23
    v_cvt_pk_bf16_f32 v55, v24, v25
    v_cvt_pk_bf16_f32 v56, v26, v27
    v_cvt_pk_bf16_f32 v57, v28, v29
    v_cvt_pk_bf16_f32 v58, v30, v31
    v_cvt_pk_bf16_f32 v59, v32, v33
    v_cvt_pk_bf16_f32 v60, v34, v35
    v_cvt_pk_bf16_f32 v61, v36, v37
    s_nop 1
    v_mfma_f32_32x32x16_bf16 v[70:85], v[94:97], v[54:57], v[70:85]
    v_mfma_f32_32x32x16_bf16 v[70:85], v[98:101], v[58:61], v[70:85]
    s_cmp_lg_u32 s56, 16
    s_cbranch_scc1 L_slow_main_34
    s_nop 7
    s_branch L_fin_30
L_fin_ok_32:
    s_cmp_lg_u32 s3, 0
    s_cbranch_scc1 L_P3_notw0_35
    s_lshl_b32 s36, s33, 4
    s_add_u32 s37, s36, s32
    s_lshl_b32 s37, s37, 7
    s_add_u32 s37, s37, 12681216
    v_mov_b32 v116, s37
    v_mov_b32 v117, s34
    s_mov_b64 exec, 1
    buffer_store_dword v117, v116, s[16:19], 0 offen sc1
    s_mov_b64 exec, -1
L_P3_notw0_35:
    s_mov_b32 s63, 393216
    s_add_u32 m0, s62, 0
    s_nop 0
    buffer_load_dwordx4 v120, s[20:23], s63 offen lds
    buffer_load_dwordx4 v121, s[20:23], s63 offen offset:1024 lds
    s_add_u32 s63, s63, 131072
    s_and_b32 s38, s3, 1
    s_bfe_u32 s39, s3, 0x10001
    s_lshr_b32 s45, s3, 2
    v_lshrrev_b32 v93, 5, v0
    v_bfe_u32 v90, v0, 2, 2
    v_lshl_add_u32 v90, v93, 2, v90
    v_lshlrev_b32 v90, 6, v90
    v_bfe_u32 v93, v0, 4, 1
    v_lshl_add_u32 v90, v93, 5, v90
    v_and_b32 v93, 3, v0
    v_lshl_add_u32 v90, v93, 3, v90
    s_lshl_b32 s36, s39, 13
    v_add_u32 v90, s36, v90
    s_lshl_b32 s36, s45, 1
    s_add_u32 s37, s36, 2
    s_and_b32 s37, s37, 3
    s_lshl_b32 s37, s37, 14
    v_add_u32 v91, s37, v90
    s_add_u32 s37, s36, 1
    s_lshl_b32 s37, s37, 14
    v_add_u32 v90, s37, v90
    s_lshr_b32 s36, s32, 3
    s_lshl_b32 s37, s33, 1
    s_add_u32 s36, s36, s37
    s_lshl_b32 s46, s36, 6
    s_lshl_b32 s47, s36, 16
    s_add_u32 s47, s47, 4194304
    s_and_b32 s36, s3, 1
    s_lshl_b32 s36, s36, 15
    s_bfe_u32 s37, s3, 0x10001
    s_lshl_b32 s37, s37, 14
    s_add_u32 s36, s36, s37
    s_lshr_b32 s37, s3, 2
    s_lshl_b32 s37, s37, 12
    s_add_u32 s48, s36, s37
    v_lshlrev_b32 v95, 4, v0
    s_lshl_b32 s36, s38, 15
    s_lshl_b32 s37, s45, 14
    s_add_u32 s36, s36, s37
    v_add_u32 v94, s36, v95
    v_lshrrev_b32 v93, 5, v0
    v_lshlrev_b32 v93, 14, v93
    v_and_b32 v92, 31, v0
    v_lshl_add_u32 v93, v92, 2, v93
    s_lshl_b32 s36, s38, 5
    s_add_u32 s36, s36, s46
    s_lshl_b32 s37, s45, 4
    s_add_u32 s36, s36, s37
    s_lshl_b32 s36, s36, 12
    s_and_b32 s37, s32, 7
    s_lshl_b32 s37, s37, 8
    s_add_u32 s36, s36, s37
    s_lshl_b32 s37, s39, 7
    s_add_u32 s46, s36, s37
    s_waitcnt vmcnt(0)
    s_barrier
    ds_read_b64_tr_b16 v[2:3], v90 offset:0
    ds_read_b64_tr_b16 v[4:5], v90 offset:512
    ds_read_b64_tr_b16 v[6:7], v90 offset:1024
    ds_read_b64_tr_b16 v[8:9], v90 offset:1536
    ds_read_b64_tr_b16 v[10:11], v90 offset:2048
    ds_read_b64_tr_b16 v[12:13], v90 offset:2560
    ds_read_b64_tr_b16 v[14:15], v90 offset:3072
    ds_read_b64_tr_b16 v[16:17], v90 offset:3584
    ds_read_b64_tr_b16 v[18:19], v90 offset:4096
    ds_read_b64_tr_b16 v[20:21], v90 offset:4608
    ds_read_b64_tr_b16 v[22:23], v90 offset:5120
    ds_read_b64_tr_b16 v[24:25], v90 offset:5632
    ds_read_b64_tr_b16 v[26:27], v90 offset:6144
    ds_read_b64_tr_b16 v[28:29], v90 offset:6656
    ds_read_b64_tr_b16 v[30:31], v90 offset:7168
    ds_read_b64_tr_b16 v[32:33], v90 offset:7680
    ds_read_b64_tr_b16 v[34:35], v91 offset:0
    ds_read_b64_tr_b16 v[36:37], v91 offset:512
    ds_read_b64_tr_b16 v[38:39], v91 offset:1024
    ds_read_b64_tr_b16 v[40:41], v91 offset:1536
    ds_read_b64_tr_b16 v[42:43], v91 offset:2048
    ds_read_b64_tr_b16 v[44:45], v91 offset:2560
    ds_read_b64_tr_b16 v[46:47], v91 offset:3072
    ds_read_b64_tr_b16 v[48:49], v91 offset:3584
    ds_read_b64_tr_b16 v[50:51], v91 offset:4096
    ds_read_b64_tr_b16 v[52:53], v91 offset:4608
    ds_read_b64_tr_b16 v[54:55], v91 offset:5120
    ds_read_b64_tr_b16 v[56:57], v91 offset:5632
    ds_read_b64_tr_b16 v[58:59], v91 offset:6144
    ds_read_b64_tr_b16 v[60:61], v91 offset:6656
    ds_read_b64_tr_b16 v[62:63], v91 offset:7168
    ds_read_b64_tr_b16 v[64:65], v91 offset:7680
    s_cmp_lg_u32 s3, 0
    s_cbranch_scc1 L_P3_nopoll_36
    s_lshl_b32 s36, s33, 11
    s_add_u32 s36, s36, 12681216
    v_and_b32 v116, 15, v0
    v_lshlrev_b32 v116, 7, v116
    v_add_u32 v116, s36, v116
    s_mov_b32 s35, 400000
L_poll_F4_37:
    buffer_load_dword v117, v116, s[16:19], 0 offen sc1
    s_waitcnt vmcnt(0)
    v_cmp_ne_u32 vcc, s34, v117
    s_nop 4
    s_cbranch_vccz L_polld_F4_38
    s_sub_u32 s35, s35, 1
    s_cmp_lg_u32 s35, 0
    s_cbranch_scc1 L_poll_F4_37
L_polld_F4_38:
L_P3_nopoll_36:
    s_waitcnt lgkmcnt(0)
    s_barrier
    s_add_u32 s36, s48, 0
    s_mov_b32 m0, s36
    s_add_u32 s36, s36, s47
    buffer_load_dwordx4 v95, s[16:19], s36 offen offset:0 sc1 lds
    buffer_load_dwordx4 v95, s[16:19], s36 offen offset:1024 sc1 lds
    buffer_load_dwordx4 v95, s[16:19], s36 offen offset:2048 sc1 lds
    buffer_load_dwordx4 v95, s[16:19], s36 offen offset:3072 sc1 lds
    s_add_u32 s36, s48, 8192
    s_mov_b32 m0, s36
    s_add_u32 s36, s36, s47
    buffer_load_dwordx4 v95, s[16:19], s36 offen offset:0 sc1 lds
    buffer_load_dwordx4 v95, s[16:19], s36 offen offset:1024 sc1 lds
    buffer_load_dwordx4 v95, s[16:19], s36 offen offset:2048 sc1 lds
    buffer_load_dwordx4 v95, s[16:19], s36 offen offset:3072 sc1 lds
    s_waitcnt vmcnt(4)
    s_barrier
    ds_read_b128 v[96:99], v94 offset:0
    ds_read_b128 v[100:103], v94 offset:1024
    ds_read_b128 v[104:107], v94 offset:2048
    ds_read_b128 v[108:111], v94 offset:3072
    ds_read_b128 v[112:115], v94 offset:4096
    ds_read_b128 v[116:119], v94 offset:5120
    ds_read_b128 v[120:123], v94 offset:6144
    ds_read_b128 v[124:127], v94 offset:7168
    s_waitcnt lgkmcnt(7)
    v_mfma_f32_32x32x16_bf16 v[66:81], v[96:99], v[2:5], 0
    s_waitcnt lgkmcnt(6)
    v_mfma_f32_32x32x16_bf16 v[66:81], v[100:103], v[6:9], v[66:81]
    s_waitcnt lgkmcnt(5)
    v_mfma_f32_32x32x16_bf16 v[66:81], v[104:107], v[10:13], v[66:81]
    s_waitcnt lgkmcnt(4)
    v_mfma_f32_32x32x16_bf16 v[66:81], v[108:111], v[14:17], v[66:81]
    s_waitcnt lgkmcnt(3)
    v_mfma_f32_32x32x16_bf16 v[66:81], v[112:115], v[18:21], v[66:81]
    s_waitcnt lgkmcnt(2)
    v_mfma_f32_32x32x16_bf16 v[66:81], v[116:119], v[22:25], v[66:81]
    s_waitcnt lgkmcnt(1)
    v_mfma_f32_32x32x16_bf16 v[66:81], v[120:123], v[26:29], v[66:81]
    s_waitcnt lgkmcnt(0)
    v_mfma_f32_32x32x16_bf16 v[66:81], v[124:127], v[30:33], v[66:81]
    s_waitcnt vmcnt(0)
    s_barrier
    ds_read_b128 v[96:99], v94 offset:8192
    ds_read_b128 v[100:103], v94 offset:9216
    ds_read_b128 v[104:107], v94 offset:10240
    ds_read_b128 v[108:111], v94 offset:11264
    ds_read_b128 v[112:115], v94 offset:12288
    ds_read_b128 v[116:119], v94 offset:13312
    ds_read_b128 v[120:123], v94 offset:14336
    ds_read_b128 v[124:127], v94 offset:15360
    s_waitcnt lgkmcnt(7)
    v_mfma_f32_32x32x16_bf16 v[66:81], v[96:99], v[34:37], v[66:81]
    s_waitcnt lgkmcnt(6)
    v_mfma_f32_32x32x16_bf16 v[66:81], v[100:103], v[38:41], v[66:81]
    s_waitcnt lgkmcnt(5)
    v_mfma_f32_32x32x16_bf16 v[66:81], v[104:107], v[42:45], v[66:81]
    s_waitcnt lgkmcnt(4)
    v_mfma_f32_32x32x16_bf16 v[66:81], v[108:111], v[46:49], v[66:81]
    s_waitcnt lgkmcnt(3)
    v_mfma_f32_32x32x16_bf16 v[66:81], v[112:115], v[50:53], v[66:81]
    s_waitcnt lgkmcnt(2)
    v_mfma_f32_32x32x16_bf16 v[66:81], v[116:119], v[54:57], v[66:81]
    s_waitcnt lgkmcnt(1)
    v_mfma_f32_32x32x16_bf16 v[66:81], v[120:123], v[58:61], v[66:81]
    s_waitcnt lgkmcnt(0)
    v_mfma_f32_32x32x16_bf16 v[66:81], v[124:127], v[62:65], v[66:81]
    s_and_b32 s36, s3, 3
    s_lshl_b32 s36, s36, 12
    s_add_u32 s36, s36, 65536
    s_lshl_b32 s37, s45, 11
    s_add_u32 s37, s37, s36
    v_add_u32 v90, s37, v95
    s_xor_b32 s37, s45, 1
    s_lshl_b32 s37, s37, 11
    s_add_u32 s37, s37, s36
    v_add_u32 v91, s37, v95
    s_nop 4
    s_cmp_eq_u32 s45, 1
    s_cbranch_scc1 L_P3_kh1_39
    ds_write_b128 v90, v[74:77]
    ds_write_b128 v90, v[78:81] offset:1024
    s_branch L_P3_sent_40
L_P3_kh1_39:
    ds_write_b128 v90, v[66:69]
    ds_write_b128 v90, v[70:73] offset:1024
    s_nop 1
    v_mov_b32 v66, v74
    v_mov_b32 v67, v75
    v_mov_b32 v68, v76
    v_mov_b32 v69, v77
    v_mov_b32 v70, v78
    v_mov_b32 v71, v79
    v_mov_b32 v72, v80
    v_mov_b32 v73, v81
L_P3_sent_40:
    s_waitcnt lgkmcnt(0)
    s_barrier
    ds_read_b128 v[82:85], v91
    ds_read_b128 v[86:89], v91 offset:1024
    s_waitcnt lgkmcnt(0)
    v_add_f32 v66, v66, v82
    v_add_f32 v67, v67, v83
    v_add_f32 v68, v68, v84
    v_add_f32 v69, v69, v85
    v_add_f32 v70, v70, v86
    v_add_f32 v71, v71, v87
    v_add_f32 v72, v72, v88
    v_add_f32 v73, v73, v89
    buffer_store_dword v66, v93, s[24:27], s46 offen nt
    s_add_u32 s37, s46, 4096
    buffer_store_dword v67, v93, s[24:27], s37 offen nt
    s_add_u32 s37, s46, 8192
    buffer_store_dword v68, v93, s[24:27], s37 offen nt
    s_add_u32 s37, s46, 12288
    buffer_store_dword v69, v93, s[24:27], s37 offen nt
    s_add_u32 s37, s46, 32768
    buffer_store_dword v70, v93, s[24:27], s37 offen nt
    s_add_u32 s37, s46, 36864
    buffer_store_dword v71, v93, s[24:27], s37 offen nt
    s_add_u32 s37, s46, 40960
    buffer_store_dword v72, v93, s[24:27], s37 offen nt
    s_add_u32 s37, s46, 45056
    buffer_store_dword v73, v93, s[24:27], s37 offen nt
    s_endpgm
L_B:
    s_sub_u32 s2, s2, 256
    s_load_dwordx2 s[8:9], s[0:1], 24
    s_load_dwordx2 s[56:57], s[0:1], 32
    s_load_dwordx2 s[60:61], s[0:1], 40
    s_load_dwordx2 s[12:13], s[0:1], 48
    s_load_dwordx2 s[20:21], s[0:1], 56
    s_load_dwordx2 s[48:49], s[0:1], 64
    s_load_dwordx2 s[52:53], s[0:1], 72
    s_load_dwordx2 s[64:65], s[0:1], 80
    s_load_dwordx2 s[68:69], s[0:1], 88
    s_load_dwordx2 s[24:25], s[0:1], 96
    s_load_dwordx2 s[28:29], s[0:1], 104
    s_load_dwordx2 s[16:17], s[0:1], 112
    s_load_dwordx2 s[40:41], s[0:1], 0
    s_load_dwordx2 s[44:45], s[0:1], 8
    s_mov_b32 s42, 0x200000
    s_mov_b32 s43, 0x00020000
    s_mov_b32 s46, 0x180000
    s_mov_b32 s47, 0x00020000
    s_mov_b32 s10, 0x200000
    s_mov_b32 s11, 0x00020000
    s_mov_b32 s14, 0x80000
    s_mov_b32 s15, 0x00020000
    s_mov_b32 s22, 0x80000
    s_mov_b32 s23, 0x00020000
    s_mov_b32 s50, 0x80000
    s_mov_b32 s51, 0x00020000
    s_mov_b32 s54, 0x80000
    s_mov_b32 s55, 0x00020000
    s_mov_b32 s58, 0x400
    s_mov_b32 s59, 0x00020000
    s_mov_b32 s62, 0x400
    s_mov_b32 s63, 0x00020000
    s_mov_b32 s66, 0x400
    s_mov_b32 s67, 0x00020000
    s_mov_b32 s70, 0x400
    s_mov_b32 s71, 0x00020000
    s_mov_b32 s26, 0x800000
    s_mov_b32 s27, 0x00020000
    s_mov_b32 s30, 0x100
    s_mov_b32 s31, 0x00020000
    s_mov_b32 s18, 0x1000000
    s_mov_b32 s19, 0x00020000
    s_and_b32 s32, s2, 7
    s_lshr_b32 s36, s2, 7
    s_lshl_b32 s36, s36, 3
    s_add_u32 s32, s32, s36
    s_lshr_b32 s33, s2, 3
    s_and_b32 s33, s33, 15
    s_waitcnt lgkmcnt(0)
    s_cmp_lg_u32 s3, 7
    s_cbranch_scc1 L_B_nopc_41
    s_getpc_b64 s[38:39]
L_pc_42:
    s_sub_u32 s38, s38, L_pc_42-concat_heads__softmax_full_mha__ssm_conv_s5__prompt_kernel
    s_subb_u32 s39, s39, 0
    s_lshr_b32 s36, s2, 3
    s_lshl_b32 s36, s36, 10
    v_and_b32 v100, 7, v0
    v_lshlrev_b32 v100, 7, v100
    v_add_u32 v100, s36, v100
    v_min_u32 v100, L_end-concat_heads__softmax_full_mha__ssm_conv_s5__prompt_kernel, v100
    global_load_dword v104, v100, s[38:39]
L_B_nopc_41:
    s_cmp_lt_u32 s3, 4
    s_cbranch_scc1 L_B_nopf_43
    s_lshr_b32 s36, s2, 3
    s_cmp_lg_u32 s3, 4
    s_cbranch_scc1 L_B_pfw_44
    s_bfe_u32 s37, s2, 0x20001
    s_lshl_b32 s37, s37, 9
    s_lshl_b32 s36, s36, 4
    s_add_u32 s36, s36, s37
    v_and_b32 v100, 15, v0
    v_add_u32 v100, s36, v100
    v_lshlrev_b32 v100, 10, v100
    v_lshrrev_b32 v101, 4, v0
    v_lshl_add_u32 v100, v101, 7, v100
    buffer_load_dword v102, v100, s[40:43], 0 offen
    buffer_load_dword v103, v100, s[40:43], 0 offen offset:512
    s_branch L_B_nopf_43
L_B_pfw_44:
    s_lshl_b32 s36, s36, 4
    v_lshrrev_b32 v100, 2, v0
    v_add_u32 v100, s36, v100
    v_mul_u32_u24 v100, 3072, v100
    s_sub_u32 s37, s3, 5
    s_lshl_b32 s37, s37, 10
    s_and_b32 s38, s2, 1
    s_lshl_b32 s38, s38, 9
    s_add_u32 s37, s37, s38
    v_and_b32 v101, 3, v0
    v_lshl_add_u32 v100, v101, 7, v100
    buffer_load_dword v102, v100, s[44:47], s37 offen
L_B_nopf_43:
    s_cmp_ge_u32 s3, 4
    s_cbranch_scc1 L_end
    v_and_b32 v12, 31, v0
    s_lshl_b32 s36, s33, 5
    v_add_u32 v12, s36, v12
    v_lshlrev_b32 v13, 1, v12
    buffer_load_ushort v122, v13, s[56:59], 0 offen
    buffer_load_ushort v123, v13, s[60:63], 0 offen
    buffer_load_ushort v124, v13, s[64:67], 0 offen
    v_lshrrev_b32 v17, 5, v0
    v_lshlrev_b32 v17, 2, v17
    s_lshl_b32 s36, s32, 5
    s_lshl_b32 s37, s3, 3
    s_add_u32 s36, s36, s37
    v_add_u32 v17, s36, v17
    v_lshl_add_u32 v18, v17, 10, v13
    buffer_load_ushort v108, v18, s[48:51], 0 offen offset:0
    buffer_load_ushort v112, v18, s[52:55], 0 offen offset:0
    buffer_load_ushort v109, v18, s[48:51], 0 offen offset:1024
    buffer_load_ushort v113, v18, s[52:55], 0 offen offset:1024
    buffer_load_ushort v110, v18, s[48:51], 0 offen offset:2048
    buffer_load_ushort v114, v18, s[52:55], 0 offen offset:2048
    buffer_load_ushort v111, v18, s[48:51], 0 offen offset:3072
    buffer_load_ushort v115, v18, s[52:55], 0 offen offset:3072
    v_mul_u32_u24 v120, 2176, v17
    v_lshl_add_u32 v120, v12, 2, v120
    s_cmp_ge_u32 s3, 2
    s_cselect_b32 s12, s20, s12
    s_cselect_b32 s13, s21, s13
    v_lshrrev_b32 v14, 3, v0
    s_lshl_b32 s36, s32, 7
    s_lshl_b32 s37, s3, 5
    s_add_u32 s36, s36, s37
    v_add_u32 v15, s36, v14
    v_lshlrev_b32 v15, 10, v15
    v_lshrrev_b32 v12, 4, v0
    v_and_b32 v13, 7, v0
    v_xor_b32 v12, v12, v13
    v_lshlrev_b32 v76, 4, v12
    v_add_u32 v76, v76, v15
    v_lshrrev_b32 v12, 4, v0
    v_add_u32 v12, 4, v12
    v_and_b32 v13, 7, v0
    v_xor_b32 v12, v12, v13
    v_lshlrev_b32 v77, 4, v12
    v_add_u32 v77, v77, v15
    v_add_u32 v78, 14336, v76
    v_add_u32 v79, 21504, v77
    v_add_u32 v77, 7168, v77
    s_lshl_b32 s36, s33, 5
    s_and_b32 s37, s3, 1
    s_lshl_b32 s37, s37, 4
    s_add_u32 s36, s36, s37
    v_add_u32 v15, s36, v14
    v_lshlrev_b32 v15, 10, v15
    v_lshrrev_b32 v12, 4, v0
    v_and_b32 v13, 7, v0
    v_xor_b32 v12, v12, v13
    v_lshlrev_b32 v80, 4, v12
    v_add_u32 v80, v80, v15
    v_lshrrev_b32 v12, 4, v0
    v_add_u32 v12, 4, v12
    v_and_b32 v13, 7, v0
    v_xor_b32 v12, v12, v13
    v_lshlrev_b32 v81, 4, v12
    v_add_u32 v81, v81, v15
    v_add_u32 v81, 7168, v81
    v_bfe_u32 v14, v0, 2, 1
    v_lshlrev_b32 v14, 4, v14
    v_and_b32 v15, 3, v0
    v_add_u32 v14, v14, v15
    v_bfe_u32 v15, v0, 3, 2
    v_lshl_add_u32 v14, v15, 2, v14
    s_lshl_b32 s36, s3, 5
    v_add_u32 v14, s36, v14
    v_bfe_u32 v12, v14, 1, 3
    v_lshrrev_b32 v13, 5, v0
    v_xor_b32 v12, v12, v13
    v_lshlrev_b32 v12, 4, v12
    v_lshl_add_u32 v82, v14, 7, v12
    v_xor_b32 v83, 32, v82
    v_xor_b32 v84, 64, v82
    v_xor_b32 v85, 96, v82
    v_and_b32 v14, 31, v0
    v_bfe_u32 v12, v14, 1, 3
    v_lshrrev_b32 v13, 5, v0
    v_xor_b32 v12, v12, v13
    v_lshlrev_b32 v12, 4, v12
    v_lshl_add_u32 v86, v14, 7, v12
    v_xor_b32 v87, 32, v86
    v_xor_b32 v88, 64, v86
    v_xor_b32 v89, 96, v86
    v_add_u32 v86, 16384, v86
    v_add_u32 v87, 16384, v87
    v_add_u32 v88, 16384, v88
    v_add_u32 v89, 16384, v89
    s_waitcnt vmcnt(0)
    v_lshlrev_b32 v122, 16, v122
    v_lshlrev_b32 v123, 16, v123
    v_lshlrev_b32 v124, 16, v124
    v_mul_f32 v124, 0x3fb8aa3b, v124
    v_exp_f32 v124, v124
    s_nop 0
    v_cvt_pk_bf16_f32 v124, v124, v124
    v_lshlrev_b32 v124, 16, v124
    v_mul_f32 v12, v124, v122
    v_mul_f32 v13, v124, v123
    v_mul_f32 v12, 0x3fb8aa3b, v12
    v_exp_f32 v12, v12
    v_mul_f32 v13, 0.15915494, v13
    v_fract_f32 v13, v13
    v_cos_f32 v2, v13
    v_sin_f32 v3, v13
    s_nop 0
    v_mul_f32 v2, v12, v2
    v_mul_f32 v3, v12, v3
    v_add_f32 v12, -1.0, v2
    v_mul_f32 v13, v122, v122
    v_fma_f32 v13, v123, v123, v13
    v_rcp_f32 v13, v13
    v_mul_f32 v4, v12, v122
    v_fma_f32 v4, v3, v123, v4
    v_mul_f32 v5, v3, v122
    v_fma_f32 v5, -v12, v123, v5
    v_add_f32 v13, v13, v13
    v_mul_f32 v4, v13, v4
    v_mul_f32 v5, v13, v5
    v_lshlrev_b32 v108, 16, v108
    v_lshlrev_b32 v112, 16, v112
    v_mul_f32 v12, v108, v4
    v_fma_f32 v12, -v112, v5, v12
    v_mul_f32 v13, v108, v5
    v_fma_f32 v13, v112, v4, v13
    v_cvt_pk_bf16_f32 v116, v12, -v13
    v_lshlrev_b32 v109, 16, v109
    v_lshlrev_b32 v113, 16, v113
    v_mul_f32 v12, v109, v4
    v_fma_f32 v12, -v113, v5, v12
    v_mul_f32 v13, v109, v5
    v_fma_f32 v13, v113, v4, v13
    v_cvt_pk_bf16_f32 v117, v12, -v13
    v_lshlrev_b32 v110, 16, v110
    v_lshlrev_b32 v114, 16, v114
    v_mul_f32 v12, v110, v4
    v_fma_f32 v12, -v114, v5, v12
    v_mul_f32 v13, v110, v5
    v_fma_f32 v13, v114, v4, v13
    v_cvt_pk_bf16_f32 v118, v12, -v13
    v_lshlrev_b32 v111, 16, v111
    v_lshlrev_b32 v115, 16, v115
    v_mul_f32 v12, v111, v4
    v_fma_f32 v12, -v115, v5, v12
    v_mul_f32 v13, v111, v5
    v_fma_f32 v13, v115, v4, v13
    v_cvt_pk_bf16_f32 v119, v12, -v13
    v_mul_f32 v14, v3, v3
    v_fma_f32 v12, v2, v2, -v14
    v_mul_f32 v14, v2, v3
    v_add_f32 v13, v14, v14
    v_mul_f32 v14, v13, v13
    v_fma_f32 v15, v12, v12, -v14
    v_mul_f32 v14, v12, v13
    v_add_f32 v16, v14, v14
    v_mul_f32 v14, v16, v16
    v_fma_f32 v12, v15, v15, -v14
    v_mul_f32 v14, v15, v16
    v_add_f32 v13, v14, v14
    v_mul_f32 v14, v13, v13
    v_fma_f32 v6, v12, v12, -v14
    v_mul_f32 v14, v12, v13
    v_add_f32 v7, v14, v14
    v_mul_f32 v14, v7, v7
    v_fma_f32 v8, v6, v6, -v14
    v_mul_f32 v14, v6, v7
    v_add_f32 v9, v14, v14
    v_mul_f32 v14, v9, v9
    v_fma_f32 v12, v8, v8, -v14
    v_mul_f32 v14, v8, v9
    v_add_f32 v13, v14, v14
    v_mul_f32 v14, v13, v13
    v_fma_f32 v10, v12, v12, -v14
    v_mul_f32 v14, v12, v13
    v_add_f32 v11, v14, v14
    v_mov_b32 v12, 0
    s_mov_b32 s35, 400000
L_nonce_Bg_45:
    buffer_load_dword v13, v12, s[28:31], 0 offen sc1
    s_waitcnt vmcnt(0)
    v_readfirstlane_b32 s34, v13
    s_cmp_lg_u32 s34, 0
    s_cbranch_scc1 L_nonced_Bg_46
    s_sub_u32 s35, s35, 1
    s_cmp_lg_u32 s35, 0
    s_cbranch_scc1 L_nonce_Bg_45
L_nonced_Bg_46:
    s_lshl_b32 s36, s2, 7
    s_add_u32 s36, s36, 12746752
    v_mov_b32 v12, s36
    s_mov_b32 s35, 2000
L_gate1_47:
    buffer_load_dword v13, v12, s[16:19], 0 offen sc1
    s_waitcnt vmcnt(0)
    v_readfirstlane_b32 s37, v13
    s_cmp_eq_u32 s37, s34
    s_cbranch_scc1 L_gated1_48
    s_sub_u32 s35, s35, 1
    s_cmp_lg_u32 s35, 0
    s_cbranch_scc1 L_gate1_47
L_gated1_48:
    s_lshl_b32 s41, s3, 12
    s_add_u32 m0, s41, 0
    s_mov_b32 s40, 0
    buffer_load_dwordx4 v76, s[8:11], s40 offen lds
    buffer_load_dwordx4 v77, s[8:11], s40 offen offset:1024 lds
    buffer_load_dwordx4 v78, s[8:11], s40 offen offset:2048 lds
    buffer_load_dwordx4 v79, s[8:11], s40 offen offset:3072 lds
    s_lshl_b32 s41, s3, 11
    s_add_u32 m0, s41, 16384
    s_nop 0
    buffer_load_dwordx4 v80, s[12:15], s40 offen lds
    buffer_load_dwordx4 v81, s[12:15], s40 offen offset:1024 lds
    s_lshl_b32 s41, s3, 12
    s_add_u32 m0, s41, 24576
    s_mov_b32 s40, 128
    buffer_load_dwordx4 v76, s[8:11], s40 offen lds
    buffer_load_dwordx4 v77, s[8:11], s40 offen offset:1024 lds
    buffer_load_dwordx4 v78, s[8:11], s40 offen offset:2048 lds
    buffer_load_dwordx4 v79, s[8:11], s40 offen offset:3072 lds
    s_lshl_b32 s41, s3, 11
    s_add_u32 m0, s41, 40960
    s_nop 0
    buffer_load_dwordx4 v80, s[12:15], s40 offen lds
    buffer_load_dwordx4 v81, s[12:15], s40 offen offset:1024 lds
    s_lshl_b32 s41, s3, 12
    s_add_u32 m0, s41, 49152
    s_mov_b32 s40, 256
    buffer_load_dwordx4 v76, s[8:11], s40 offen lds
    buffer_load_dwordx4 v77, s[8:11], s40 offen offset:1024 lds
    buffer_load_dwordx4 v78, s[8:11], s40 offen offset:2048 lds
    buffer_load_dwordx4 v79, s[8:11], s40 offen offset:3072 lds
    s_lshl_b32 s41, s3, 11
    s_add_u32 m0, s41, 65536
    s_nop 0
    buffer_load_dwordx4 v80, s[12:15], s40 offen lds
    buffer_load_dwordx4 v81, s[12:15], s40 offen offset:1024 lds
    s_waitcnt vmcnt(12)
    s_barrier
    ds_read_b128 v[52:55], v82 offset:0
    ds_read_b128 v[60:63], v86 offset:0
    ds_read_b128 v[68:71], v86 offset:4096
    ds_read_b128 v[56:59], v83 offset:0
    ds_read_b128 v[64:67], v87 offset:0
    ds_read_b128 v[72:75], v87 offset:4096
    s_waitcnt lgkmcnt(3)
    v_mfma_f32_32x32x16_bf16 v[20:35], v[52:55], v[60:63], 0
    v_mfma_f32_32x32x16_bf16 v[36:51], v[52:55], v[68:71], 0
    ds_read_b128 v[52:55], v84 offset:0
    ds_read_b128 v[60:63], v88 offset:0
    ds_read_b128 v[68:71], v88 offset:4096
    s_waitcnt lgkmcnt(3)
    v_mfma_f32_32x32x16_bf16 v[20:35], v[56:59], v[64:67], v[20:35]
    v_mfma_f32_32x32x16_bf16 v[36:51], v[56:59], v[72:75], v[36:51]
    ds_read_b128 v[56:59], v85 offset:0
    ds_read_b128 v[64:67], v89 offset:0
    ds_read_b128 v[72:75], v89 offset:4096
    s_waitcnt lgkmcnt(3)
    v_mfma_f32_32x32x16_bf16 v[20:35], v[52:55], v[60:63], v[20:35]
    v_mfma_f32_32x32x16_bf16 v[36:51], v[52:55], v[68:71], v[36:51]
    s_waitcnt lgkmcnt(0)
    v_mfma_f32_32x32x16_bf16 v[20:35], v[56:59], v[64:67], v[20:35]
    v_mfma_f32_32x32x16_bf16 v[36:51], v[56:59], v[72:75], v[36:51]
    s_waitcnt vmcnt(6)
    s_barrier
    s_lshl_b32 s41, s3, 12
    s_add_u32 m0, s41, 0
    s_mov_b32 s40, 384
    buffer_load_dwordx4 v76, s[8:11], s40 offen lds
    buffer_load_dwordx4 v77, s[8:11], s40 offen offset:1024 lds
    buffer_load_dwordx4 v78, s[8:11], s40 offen offset:2048 lds
    buffer_load_dwordx4 v79, s[8:11], s40 offen offset:3072 lds
    s_lshl_b32 s41, s3, 11
    s_add_u32 m0, s41, 16384
    s_nop 0
    buffer_load_dwordx4 v80, s[12:15], s40 offen lds
    buffer_load_dwordx4 v81, s[12:15], s40 offen offset:1024 lds
    ds_read_b128 v[52:55], v82 offset:24576
    ds_read_b128 v[60:63], v86 offset:24576
    ds_read_b128 v[68:71], v86 offset:28672
    ds_read_b128 v[56:59], v83 offset:24576
    ds_read_b128 v[64:67], v87 offset:24576
    ds_read_b128 v[72:75], v87 offset:28672
    s_waitcnt lgkmcnt(3)
    v_mfma_f32_32x32x16_bf16 v[20:35], v[52:55], v[60:63], v[20:35]
    v_mfma_f32_32x32x16_bf16 v[36:51], v[52:55], v[68:71], v[36:51]
    ds_read_b128 v[52:55], v84 offset:24576
    ds_read_b128 v[60:63], v88 offset:24576
    ds_read_b128 v[68:71], v88 offset:28672
    s_waitcnt lgkmcnt(3)
    v_mfma_f32_32x32x16_bf16 v[20:35], v[56:59], v[64:67], v[20:35]
    v_mfma_f32_32x32x16_bf16 v[36:51], v[56:59], v[72:75], v[36:51]
    ds_read_b128 v[56:59], v85 offset:24576
    ds_read_b128 v[64:67], v89 offset:24576
    ds_read_b128 v[72:75], v89 offset:28672
    s_waitcnt lgkmcnt(3)
    v_mfma_f32_32x32x16_bf16 v[20:35], v[52:55], v[60:63], v[20:35]
    v_mfma_f32_32x32x16_bf16 v[36:51], v[52:55], v[68:71], v[36:51]
    s_waitcnt lgkmcnt(0)
    v_mfma_f32_32x32x16_bf16 v[20:35], v[56:59], v[64:67], v[20:35]
    v_mfma_f32_32x32x16_bf16 v[36:51], v[56:59], v[72:75], v[36:51]
    s_waitcnt vmcnt(6)
    s_barrier
    s_lshl_b32 s41, s3, 12
    s_add_u32 m0, s41, 24576
    s_mov_b32 s40, 512
    buffer_load_dwordx4 v76, s[8:11], s40 offen lds
    buffer_load_dwordx4 v77, s[8:11], s40 offen offset:1024 lds
    buffer_load_dwordx4 v78, s[8:11], s40 offen offset:2048 lds
    buffer_load_dwordx4 v79, s[8:11], s40 offen offset:3072 lds
    s_lshl_b32 s41, s3, 11
    s_add_u32 m0, s41, 40960
    s_nop 0
    buffer_load_dwordx4 v80, s[12:15], s40 offen lds
    buffer_load_dwordx4 v81, s[12:15], s40 offen offset:1024 lds
    ds_read_b128 v[52:55], v82 offset:49152
    ds_read_b128 v[60:63], v86 offset:49152
    ds_read_b128 v[68:71], v86 offset:53248
    ds_read_b128 v[56:59], v83 offset:49152
    ds_read_b128 v[64:67], v87 offset:49152
    ds_read_b128 v[72:75], v87 offset:53248
    s_waitcnt lgkmcnt(3)
    v_mfma_f32_32x32x16_bf16 v[20:35], v[52:55], v[60:63], v[20:35]
    v_mfma_f32_32x32x16_bf16 v[36:51], v[52:55], v[68:71], v[36:51]
    ds_read_b128 v[52:55], v84 offset:49152
    ds_read_b128 v[60:63], v88 offset:49152
    ds_read_b128 v[68:71], v88 offset:53248
    s_waitcnt lgkmcnt(3)
    v_mfma_f32_32x32x16_bf16 v[20:35], v[56:59], v[64:67], v[20:35]
    v_mfma_f32_32x32x16_bf16 v[36:51], v[56:59], v[72:75], v[36:51]
    ds_read_b128 v[56:59], v85 offset:49152
    ds_read_b128 v[64:67], v89 offset:49152
    ds_read_b128 v[72:75], v89 offset:53248
    s_waitcnt lgkmcnt(3)
    v_mfma_f32_32x32x16_bf16 v[20:35], v[52:55], v[60:63], v[20:35]
    v_mfma_f32_32x32x16_bf16 v[36:51], v[52:55], v[68:71], v[36:51]
    s_waitcnt lgkmcnt(0)
    v_mfma_f32_32x32x16_bf16 v[20:35], v[56:59], v[64:67], v[20:35]
    v_mfma_f32_32x32x16_bf16 v[36:51], v[56:59], v[72:75], v[36:51]
    s_waitcnt vmcnt(6)
    s_barrier
    s_lshl_b32 s41, s3, 12
    s_add_u32 m0, s41, 49152
    s_mov_b32 s40, 640
    buffer_load_dwordx4 v76, s[8:11], s40 offen lds
    buffer_load_dwordx4 v77, s[8:11], s40 offen offset:1024 lds
    buffer_load_dwordx4 v78, s[8:11], s40 offen offset:2048 lds
    buffer_load_dwordx4 v79, s[8:11], s40 offen offset:3072 lds
    s_lshl_b32 s41, s3, 11
    s_add_u32 m0, s41, 65536
    s_nop 0
    buffer_load_dwordx4 v80, s[12:15], s40 offen lds
    buffer_load_dwordx4 v81, s[12:15], s40 offen offset:1024 lds
    ds_read_b128 v[52:55], v82 offset:0
    ds_read_b128 v[60:63], v86 offset:0
    ds_read_b128 v[68:71], v86 offset:4096
    ds_read_b128 v[56:59], v83 offset:0
    ds_read_b128 v[64:67], v87 offset:0
    ds_read_b128 v[72:75], v87 offset:4096
    s_waitcnt lgkmcnt(3)
    v_mfma_f32_32x32x16_bf16 v[20:35], v[52:55], v[60:63], v[20:35]
    v_mfma_f32_32x32x16_bf16 v[36:51], v[52:55], v[68:71], v[36:51]
    ds_read_b128 v[52:55], v84 offset:0
    ds_read_b128 v[60:63], v88 offset:0
    ds_read_b128 v[68:71], v88 offset:4096
    s_waitcnt lgkmcnt(3)
    v_mfma_f32_32x32x16_bf16 v[20:35], v[56:59], v[64:67], v[20:35]
    v_mfma_f32_32x32x16_bf16 v[36:51], v[56:59], v[72:75], v[36:51]
    ds_read_b128 v[56:59], v85 offset:0
    ds_read_b128 v[64:67], v89 offset:0
    ds_read_b128 v[72:75], v89 offset:4096
    s_waitcnt lgkmcnt(3)
    v_mfma_f32_32x32x16_bf16 v[20:35], v[52:55], v[60:63], v[20:35]
    v_mfma_f32_32x32x16_bf16 v[36:51], v[52:55], v[68:71], v[36:51]
    s_waitcnt lgkmcnt(0)
    v_mfma_f32_32x32x16_bf16 v[20:35], v[56:59], v[64:67], v[20:35]
    v_mfma_f32_32x32x16_bf16 v[36:51], v[56:59], v[72:75], v[36:51]
    s_waitcnt vmcnt(6)
    s_barrier
    s_lshl_b32 s41, s3, 12
    s_add_u32 m0, s41, 0
    s_mov_b32 s40, 768
    buffer_load_dwordx4 v76, s[8:11], s40 offen lds
    buffer_load_dwordx4 v77, s[8:11], s40 offen offset:1024 lds
    buffer_load_dwordx4 v78, s[8:11], s40 offen offset:2048 lds
    buffer_load_dwordx4 v79, s[8:11], s40 offen offset:3072 lds
    s_lshl_b32 s41, s3, 11
    s_add_u32 m0, s41, 16384
    s_nop 0
    buffer_load_dwordx4 v80, s[12:15], s40 offen lds
    buffer_load_dwordx4 v81, s[12:15], s40 offen offset:1024 lds
    ds_read_b128 v[52:55], v82 offset:24576
    ds_read_b128 v[60:63], v86 offset:24576
    ds_read_b128 v[68:71], v86 offset:28672
    ds_read_b128 v[56:59], v83 offset:24576
    ds_read_b128 v[64:67], v87 offset:24576
    ds_read_b128 v[72:75], v87 offset:28672
    s_waitcnt lgkmcnt(3)
    v_mfma_f32_32x32x16_bf16 v[20:35], v[52:55], v[60:63], v[20:35]
    v_mfma_f32_32x32x16_bf16 v[36:51], v[52:55], v[68:71], v[36:51]
    ds_read_b128 v[52:55], v84 offset:24576
    ds_read_b128 v[60:63], v88 offset:24576
    ds_read_b128 v[68:71], v88 offset:28672
    s_waitcnt lgkmcnt(3)
    v_mfma_f32_32x32x16_bf16 v[20:35], v[56:59], v[64:67], v[20:35]
    v_mfma_f32_32x32x16_bf16 v[36:51], v[56:59], v[72:75], v[36:51]
    ds_read_b128 v[56:59], v85 offset:24576
    ds_read_b128 v[64:67], v89 offset:24576
    ds_read_b128 v[72:75], v89 offset:28672
    s_waitcnt lgkmcnt(3)
    v_mfma_f32_32x32x16_bf16 v[20:35], v[52:55], v[60:63], v[20:35]
    v_mfma_f32_32x32x16_bf16 v[36:51], v[52:55], v[68:71], v[36:51]
    s_waitcnt lgkmcnt(0)
    v_mfma_f32_32x32x16_bf16 v[20:35], v[56:59], v[64:67], v[20:35]
    v_mfma_f32_32x32x16_bf16 v[36:51], v[56:59], v[72:75], v[36:51]
    s_waitcnt vmcnt(6)
    s_barrier
    s_lshl_b32 s41, s3, 12
    s_add_u32 m0, s41, 24576
    s_mov_b32 s40, 896
    buffer_load_dwordx4 v76, s[8:11], s40 offen lds
    buffer_load_dwordx4 v77, s[8:11], s40 offen offset:1024 lds
    buffer_load_dwordx4 v78, s[8:11], s40 offen offset:2048 lds
    buffer_load_dwordx4 v79, s[8:11], s40 offen offset:3072 lds
    s_lshl_b32 s41, s3, 11
    s_add_u32 m0, s41, 40960
    s_nop 0
    buffer_load_dwordx4 v80, s[12:15], s40 offen lds
    buffer_load_dwordx4 v81, s[12:15], s40 offen offset:1024 lds
    ds_read_b128 v[52:55], v82 offset:49152
    ds_read_b128 v[60:63], v86 offset:49152
    ds_read_b128 v[68:71], v86 offset:53248
    ds_read_b128 v[56:59], v83 offset:49152
    ds_read_b128 v[64:67], v87 offset:49152
    ds_read_b128 v[72:75], v87 offset:53248
    s_waitcnt lgkmcnt(3)
    v_mfma_f32_32x32x16_bf16 v[20:35], v[52:55], v[60:63], v[20:35]
    v_mfma_f32_32x32x16_bf16 v[36:51], v[52:55], v[68:71], v[36:51]
    ds_read_b128 v[52:55], v84 offset:49152
    ds_read_b128 v[60:63], v88 offset:49152
    ds_read_b128 v[68:71], v88 offset:53248
    s_waitcnt lgkmcnt(3)
    v_mfma_f32_32x32x16_bf16 v[20:35], v[56:59], v[64:67], v[20:35]
    v_mfma_f32_32x32x16_bf16 v[36:51], v[56:59], v[72:75], v[36:51]
    ds_read_b128 v[56:59], v85 offset:49152
    ds_read_b128 v[64:67], v89 offset:49152
    ds_read_b128 v[72:75], v89 offset:53248
    s_waitcnt lgkmcnt(3)
    v_mfma_f32_32x32x16_bf16 v[20:35], v[52:55], v[60:63], v[20:35]
    v_mfma_f32_32x32x16_bf16 v[36:51], v[52:55], v[68:71], v[36:51]
    s_waitcnt lgkmcnt(0)
    v_mfma_f32_32x32x16_bf16 v[20:35], v[56:59], v[64:67], v[20:35]
    v_mfma_f32_32x32x16_bf16 v[36:51], v[56:59], v[72:75], v[36:51]
    s_waitcnt vmcnt(6)
    s_barrier
    ds_read_b128 v[52:55], v82 offset:0
    ds_read_b128 v[60:63], v86 offset:0
    ds_read_b128 v[68:71], v86 offset:4096
    ds_read_b128 v[56:59], v83 offset:0
    ds_read_b128 v[64:67], v87 offset:0
    ds_read_b128 v[72:75], v87 offset:4096
    s_waitcnt lgkmcnt(3)
    v_mfma_f32_32x32x16_bf16 v[20:35], v[52:55], v[60:63], v[20:35]
    v_mfma_f32_32x32x16_bf16 v[36:51], v[52:55], v[68:71], v[36:51]
    ds_read_b128 v[52:55], v84 offset:0
    ds_read_b128 v[60:63], v88 offset:0
    ds_read_b128 v[68:71], v88 offset:4096
    s_waitcnt lgkmcnt(3)
    v_mfma_f32_32x32x16_bf16 v[20:35], v[56:59], v[64:67], v[20:35]
    v_mfma_f32_32x32x16_bf16 v[36:51], v[56:59], v[72:75], v[36:51]
    ds_read_b128 v[56:59], v85 offset:0
    ds_read_b128 v[64:67], v89 offset:0
    ds_read_b128 v[72:75], v89 offset:4096
    s_waitcnt lgkmcnt(3)
    v_mfma_f32_32x32x16_bf16 v[20:35], v[52:55], v[60:63], v[20:35]
    v_mfma_f32_32x32x16_bf16 v[36:51], v[52:55], v[68:71], v[36:51]
    s_waitcnt lgkmcnt(0)
    v_mfma_f32_32x32x16_bf16 v[20:35], v[56:59], v[64:67], v[20:35]
    v_mfma_f32_32x32x16_bf16 v[36:51], v[56:59], v[72:75], v[36:51]
    s_waitcnt vmcnt(0)
    s_barrier
    ds_read_b128 v[52:55], v82 offset:24576
    ds_read_b128 v[60:63], v86 offset:24576
    ds_read_b128 v[68:71], v86 offset:28672
    ds_read_b128 v[56:59], v83 offset:24576
    ds_read_b128 v[64:67], v87 offset:24576
    ds_read_b128 v[72:75], v87 offset:28672
    s_waitcnt lgkmcnt(3)
    v_mfma_f32_32x32x16_bf16 v[20:35], v[52:55], v[60:63], v[20:35]
    v_mfma_f32_32x32x16_bf16 v[36:51], v[52:55], v[68:71], v[36:51]
    ds_read_b128 v[52:55], v84 offset:24576
    ds_read_b128 v[60:63], v88 offset:24576
    ds_read_b128 v[68:71], v88 offset:28672
    s_waitcnt lgkmcnt(3)
    v_mfma_f32_32x32x16_bf16 v[20:35], v[56:59], v[64:67], v[20:35]
    v_mfma_f32_32x32x16_bf16 v[36:51], v[56:59], v[72:75], v[36:51]
    ds_read_b128 v[56:59], v85 offset:24576
    ds_read_b128 v[64:67], v89 offset:24576
    ds_read_b128 v[72:75], v89 offset:28672
    s_waitcnt lgkmcnt(3)
    v_mfma_f32_32x32x16_bf16 v[20:35], v[52:55], v[60:63], v[20:35]
    v_mfma_f32_32x32x16_bf16 v[36:51], v[52:55], v[68:71], v[36:51]
    s_waitcnt lgkmcnt(0)
    v_mfma_f32_32x32x16_bf16 v[20:35], v[56:59], v[64:67], v[20:35]
    v_mfma_f32_32x32x16_bf16 v[36:51], v[56:59], v[72:75], v[36:51]
    s_setprio 2
    v_mov_b32 v12, 0
    buffer_load_dword v121, v12, s[28:31], 0 offen sc1
    s_mov_b32 s36, 11010048
    s_mov_b32 s37, 11014400
    buffer_store_dword v116, v120, s[16:19], s36 offen sc1
    buffer_store_dword v117, v120, s[16:19], s36 offen offset:2176 sc1
    buffer_store_dword v118, v120, s[16:19], s37 offen sc1
    buffer_store_dword v119, v120, s[16:19], s37 offen offset:2176 sc1
    s_nop 7
    v_mov_b32 v52, v20
    v_mov_b32 v53, v36
    v_fma_f32 v12, -v3, v53, v21
    v_fma_f32 v13, v3, v52, v37
    v_fma_f32 v52, v2, v52, v12
    v_fma_f32 v53, v2, v53, v13
    v_fma_f32 v12, -v3, v53, v22
    v_fma_f32 v13, v3, v52, v38
    v_fma_f32 v52, v2, v52, v12
    v_fma_f32 v53, v2, v53, v13
    v_fma_f32 v12, -v3, v53, v23
    v_fma_f32 v13, v3, v52, v39
    v_fma_f32 v52, v2, v52, v12
    v_fma_f32 v53, v2, v53, v13
    v_fma_f32 v12, -v3, v53, v24
    v_fma_f32 v13, v3, v52, v40
    v_fma_f32 v52, v2, v52, v12
    v_fma_f32 v53, v2, v53, v13
    v_fma_f32 v12, -v3, v53, v25
    v_fma_f32 v13, v3, v52, v41
    v_fma_f32 v52, v2, v52, v12
    v_fma_f32 v53, v2, v53, v13
    v_fma_f32 v12, -v3, v53, v26
    v_fma_f32 v13, v3, v52, v42
    v_fma_f32 v52, v2, v52, v12
    v_fma_f32 v53, v2, v53, v13
    v_fma_f32 v12, -v3, v53, v27
    v_fma_f32 v13, v3, v52, v43
    v_fma_f32 v52, v2, v52, v12
    v_fma_f32 v53, v2, v53, v13
    v_fma_f32 v12, -v3, v53, v28
    v_fma_f32 v13, v3, v52, v44
    v_fma_f32 v52, v2, v52, v12
    v_fma_f32 v53, v2, v53, v13
    v_fma_f32 v12, -v3, v53, v29
    v_fma_f32 v13, v3, v52, v45
    v_fma_f32 v52, v2, v52, v12
    v_fma_f32 v53, v2, v53, v13
    v_fma_f32 v12, -v3, v53, v30
    v_fma_f32 v13, v3, v52, v46
    v_fma_f32 v52, v2, v52, v12
    v_fma_f32 v53, v2, v53, v13
    v_fma_f32 v12, -v3, v53, v31
    v_fma_f32 v13, v3, v52, v47
    v_fma_f32 v52, v2, v52, v12
    v_fma_f32 v53, v2, v53, v13
    v_fma_f32 v12, -v3, v53, v32
    v_fma_f32 v13, v3, v52, v48
    v_fma_f32 v52, v2, v52, v12
    v_fma_f32 v53, v2, v53, v13
    v_fma_f32 v12, -v3, v53, v33
    v_fma_f32 v13, v3, v52, v49
    v_fma_f32 v52, v2, v52, v12
    v_fma_f32 v53, v2, v53, v13
    v_fma_f32 v12, -v3, v53, v34
    v_fma_f32 v13, v3, v52, v50
    v_fma_f32 v52, v2, v52, v12
    v_fma_f32 v53, v2, v53, v13
    v_fma_f32 v12, -v3, v53, v35
    v_fma_f32 v13, v3, v52, v51
    v_fma_f32 v52, v2, v52, v12
    v_fma_f32 v53, v2, v53, v13
    v_mov_b32 v54, v52
    v_mov_b32 v55, v53
    v_mov_b32 v56, v52
    v_mov_b32 v57, v53
    s_nop 1
    v_permlane32_swap_b32 v54, v56
    v_permlane32_swap_b32 v55, v57
    s_nop 1
    v_fma_f32 v12, -v7, v55, v56
    v_fma_f32 v13, v7, v54, v57
    v_fma_f32 v12, v6, v54, v12
    v_fma_f32 v59, v6, v55, v13
    v_mov_b32 v58, v12
    v_and_b32 v14, 31, v0
    v_lshlrev_b32 v14, 3, v14
    v_add_u32 v14, 73728, v14
    s_lshl_b32 s36, s3, 8
    v_add_u32 v15, s36, v14
    ds_write_b64 v15, v[58:59]
    s_waitcnt lgkmcnt(0)
    s_barrier
    ds_read_b64 v[82:83], v14 offset:0
    ds_read_b64 v[84:85], v14 offset:256
    ds_read_b64 v[86:87], v14 offset:512
    ds_read_b64 v[88:89], v14 offset:768
    v_and_b32 v60, 31, v0
    s_lshl_b32 s36, s33, 5
    v_add_u32 v60, s36, v60
    v_lshlrev_b32 v60, 3, v60
    s_waitcnt vmcnt(4) lgkmcnt(0)
    v_readfirstlane_b32 s34, v121
    s_nop 0
    s_cmp_lg_u32 s34, 0
    s_cbranch_scc1 L_B_havenonce_49
    v_mov_b32 v12, 0
    s_mov_b32 s35, 400000
L_nonce_B_50:
    buffer_load_dword v13, v12, s[28:31], 0 offen sc1
    s_waitcnt vmcnt(0)
    v_readfirstlane_b32 s34, v13
    s_cmp_lg_u32 s34, 0
    s_cbranch_scc1 L_nonced_B_51
    s_sub_u32 s35, s35, 1
    s_cmp_lg_u32 s35, 0
    s_cbranch_scc1 L_nonce_B_50
L_nonced_B_51:
L_B_havenonce_49:
    s_cmp_lg_u32 s3, 0
    s_cbranch_scc1 L_B_pubS_52
    v_mov_b32 v62, v82
    v_mov_b32 v63, v83
    v_fma_f32 v12, -v9, v63, v84
    v_fma_f32 v13, v9, v62, v85
    v_fma_f32 v12, v8, v62, v12
    v_fma_f32 v63, v8, v63, v13
    v_mov_b32 v62, v12
    v_fma_f32 v12, -v9, v63, v86
    v_fma_f32 v13, v9, v62, v87
    v_fma_f32 v12, v8, v62, v12
    v_fma_f32 v63, v8, v63, v13
    v_mov_b32 v62, v12
    v_fma_f32 v12, -v9, v63, v88
    v_fma_f32 v13, v9, v62, v89
    v_fma_f32 v12, v8, v62, v12
    v_fma_f32 v63, v8, v63, v13
    v_mov_b32 v62, v12
    s_lshl_b32 s36, s32, 12
    s_add_u32 s36, s36, 12189696
    buffer_store_dwordx2 v[62:63], v60, s[16:19], s36 offen sc1
    s_waitcnt vmcnt(0)
    s_lshl_b32 s36, s33, 4
    s_add_u32 s36, s36, s32
    s_lshl_b32 s36, s36, 7
    s_add_u32 s36, s36, 12615680
    v_mov_b32 v12, s36
    v_mov_b32 v13, s34
    s_mov_b64 exec, 1
    buffer_store_dword v13, v12, s[16:19], 0 offen sc1
    s_mov_b64 exec, -1
L_B_pubS_52:
    v_and_b32 v14, 15, v0
    v_lshlrev_b32 v15, 7, v14
    s_lshl_b32 s36, s33, 11
    s_add_u32 s36, s36, 12615680
    v_add_u32 v15, s36, v15
    v_cmp_gt_u32 s[38:39], s32, v14
    s_mov_b32 s35, 400000
L_pollF2_53:
    buffer_load_dword v16, v15, s[16:19], 0 offen sc1
    s_waitcnt vmcnt(0)
    v_cmp_ne_u32 vcc, s34, v16
    s_nop 1
    s_and_b64 vcc, vcc, s[38:39]
    s_cbranch_scc0 L_pollF2d_54
    s_sub_u32 s35, s35, 1
    s_cmp_lg_u32 s35, 0
    s_cbranch_scc1 L_pollF2_53
L_pollF2d_54:
    s_mov_b32 s36, 12189696
    s_cmp_le_u32 s32, 0
    s_cbranch_scc1 L_S_loaded_55
    buffer_load_dwordx2 v[64:65], v60, s[16:19], s36 offen sc1
    s_add_u32 s36, s36, 4096
    s_cmp_le_u32 s32, 1
    s_cbranch_scc1 L_S_loaded_55
    buffer_load_dwordx2 v[66:67], v60, s[16:19], s36 offen sc1
    s_add_u32 s36, s36, 4096
    s_cmp_le_u32 s32, 2
    s_cbranch_scc1 L_S_loaded_55
    buffer_load_dwordx2 v[68:69], v60, s[16:19], s36 offen sc1
    s_add_u32 s36, s36, 4096
    s_cmp_le_u32 s32, 3
    s_cbranch_scc1 L_S_loaded_55
    buffer_load_dwordx2 v[70:71], v60, s[16:19], s36 offen sc1
    s_add_u32 s36, s36, 4096
    s_cmp_le_u32 s32, 4
    s_cbranch_scc1 L_S_loaded_55
    buffer_load_dwordx2 v[72:73], v60, s[16:19], s36 offen sc1
    s_add_u32 s36, s36, 4096
    s_cmp_le_u32 s32, 5
    s_cbranch_scc1 L_S_loaded_55
    buffer_load_dwordx2 v[74:75], v60, s[16:19], s36 offen sc1
    s_add_u32 s36, s36, 4096
    s_cmp_le_u32 s32, 6
    s_cbranch_scc1 L_S_loaded_55
    buffer_load_dwordx2 v[76:77], v60, s[16:19], s36 offen sc1
    s_add_u32 s36, s36, 4096
    s_cmp_le_u32 s32, 7
    s_cbranch_scc1 L_S_loaded_55
    buffer_load_dwordx2 v[78:79], v60, s[16:19], s36 offen sc1
    s_add_u32 s36, s36, 4096
    s_cmp_le_u32 s32, 8
    s_cbranch_scc1 L_S_loaded_55
    buffer_load_dwordx2 v[80:81], v60, s[16:19], s36 offen sc1
    s_add_u32 s36, s36, 4096
    s_cmp_le_u32 s32, 9
    s_cbranch_scc1 L_S_loaded_55
    buffer_load_dwordx2 v[92:93], v60, s[16:19], s36 offen sc1
    s_add_u32 s36, s36, 4096
    s_cmp_le_u32 s32, 10
    s_cbranch_scc1 L_S_loaded_55
    buffer_load_dwordx2 v[94:95], v60, s[16:19], s36 offen sc1
    s_add_u32 s36, s36, 4096
    s_cmp_le_u32 s32, 11
    s_cbranch_scc1 L_S_loaded_55
    buffer_load_dwordx2 v[96:97], v60, s[16:19], s36 offen sc1
    s_add_u32 s36, s36, 4096
    s_cmp_le_u32 s32, 12
    s_cbranch_scc1 L_S_loaded_55
    buffer_load_dwordx2 v[98:99], v60, s[16:19], s36 offen sc1
    s_add_u32 s36, s36, 4096
    s_cmp_le_u32 s32, 13
    s_cbranch_scc1 L_S_loaded_55
    buffer_load_dwordx2 v[100:101], v60, s[16:19], s36 offen sc1
    s_add_u32 s36, s36, 4096
    s_cmp_le_u32 s32, 14
    s_cbranch_scc1 L_S_loaded_55
    buffer_load_dwordx2 v[102:103], v60, s[16:19], s36 offen sc1
L_S_loaded_55:
    v_mov_b32 v62, 0
    v_mov_b32 v63, 0
    s_waitcnt vmcnt(0)
    s_cmp_le_u32 s32, 0
    s_cbranch_scc1 L_carry_done_56
    v_fma_f32 v12, -v11, v63, v64
    v_fma_f32 v13, v11, v62, v65
    v_fma_f32 v12, v10, v62, v12
    v_fma_f32 v63, v10, v63, v13
    v_mov_b32 v62, v12
    s_cmp_le_u32 s32, 1
    s_cbranch_scc1 L_carry_done_56
    v_fma_f32 v12, -v11, v63, v66
    v_fma_f32 v13, v11, v62, v67
    v_fma_f32 v12, v10, v62, v12
    v_fma_f32 v63, v10, v63, v13
    v_mov_b32 v62, v12
    s_cmp_le_u32 s32, 2
    s_cbranch_scc1 L_carry_done_56
    v_fma_f32 v12, -v11, v63, v68
    v_fma_f32 v13, v11, v62, v69
    v_fma_f32 v12, v10, v62, v12
    v_fma_f32 v63, v10, v63, v13
    v_mov_b32 v62, v12
    s_cmp_le_u32 s32, 3
    s_cbranch_scc1 L_carry_done_56
    v_fma_f32 v12, -v11, v63, v70
    v_fma_f32 v13, v11, v62, v71
    v_fma_f32 v12, v10, v62, v12
    v_fma_f32 v63, v10, v63, v13
    v_mov_b32 v62, v12
    s_cmp_le_u32 s32, 4
    s_cbranch_scc1 L_carry_done_56
    v_fma_f32 v12, -v11, v63, v72
    v_fma_f32 v13, v11, v62, v73
    v_fma_f32 v12, v10, v62, v12
    v_fma_f32 v63, v10, v63, v13
    v_mov_b32 v62, v12
    s_cmp_le_u32 s32, 5
    s_cbranch_scc1 L_carry_done_56
    v_fma_f32 v12, -v11, v63, v74
    v_fma_f32 v13, v11, v62, v75
    v_fma_f32 v12, v10, v62, v12
    v_fma_f32 v63, v10, v63, v13
    v_mov_b32 v62, v12
    s_cmp_le_u32 s32, 6
    s_cbranch_scc1 L_carry_done_56
    v_fma_f32 v12, -v11, v63, v76
    v_fma_f32 v13, v11, v62, v77
    v_fma_f32 v12, v10, v62, v12
    v_fma_f32 v63, v10, v63, v13
    v_mov_b32 v62, v12
    s_cmp_le_u32 s32, 7
    s_cbranch_scc1 L_carry_done_56
    v_fma_f32 v12, -v11, v63, v78
    v_fma_f32 v13, v11, v62, v79
    v_fma_f32 v12, v10, v62, v12
    v_fma_f32 v63, v10, v63, v13
    v_mov_b32 v62, v12
    s_cmp_le_u32 s32, 8
    s_cbranch_scc1 L_carry_done_56
    v_fma_f32 v12, -v11, v63, v80
    v_fma_f32 v13, v11, v62, v81
    v_fma_f32 v12, v10, v62, v12
    v_fma_f32 v63, v10, v63, v13
    v_mov_b32 v62, v12
    s_cmp_le_u32 s32, 9
    s_cbranch_scc1 L_carry_done_56
    v_fma_f32 v12, -v11, v63, v92
    v_fma_f32 v13, v11, v62, v93
    v_fma_f32 v12, v10, v62, v12
    v_fma_f32 v63, v10, v63, v13
    v_mov_b32 v62, v12
    s_cmp_le_u32 s32, 10
    s_cbranch_scc1 L_carry_done_56
    v_fma_f32 v12, -v11, v63, v94
    v_fma_f32 v13, v11, v62, v95
    v_fma_f32 v12, v10, v62, v12
    v_fma_f32 v63, v10, v63, v13
    v_mov_b32 v62, v12
    s_cmp_le_u32 s32, 11
    s_cbranch_scc1 L_carry_done_56
    v_fma_f32 v12, -v11, v63, v96
    v_fma_f32 v13, v11, v62, v97
    v_fma_f32 v12, v10, v62, v12
    v_fma_f32 v63, v10, v63, v13
    v_mov_b32 v62, v12
    s_cmp_le_u32 s32, 12
    s_cbranch_scc1 L_carry_done_56
    v_fma_f32 v12, -v11, v63, v98
    v_fma_f32 v13, v11, v62, v99
    v_fma_f32 v12, v10, v62, v12
    v_fma_f32 v63, v10, v63, v13
    v_mov_b32 v62, v12
    s_cmp_le_u32 s32, 13
    s_cbranch_scc1 L_carry_done_56
    v_fma_f32 v12, -v11, v63, v100
    v_fma_f32 v13, v11, v62, v101
    v_fma_f32 v12, v10, v62, v12
    v_fma_f32 v63, v10, v63, v13
    v_mov_b32 v62, v12
    s_cmp_le_u32 s32, 14
    s_cbranch_scc1 L_carry_done_56
    v_fma_f32 v12, -v11, v63, v102
    v_fma_f32 v13, v11, v62, v103
    v_fma_f32 v12, v10, v62, v12
    v_fma_f32 v63, v10, v63, v13
    v_mov_b32 v62, v12
L_carry_done_56:
    s_cmp_le_u32 s3, 0
    s_cbranch_scc1 L_waves_done_57
    v_fma_f32 v12, -v9, v63, v82
    v_fma_f32 v13, v9, v62, v83
    v_fma_f32 v12, v8, v62, v12
    v_fma_f32 v63, v8, v63, v13
    v_mov_b32 v62, v12
    s_cmp_le_u32 s3, 1
    s_cbranch_scc1 L_waves_done_57
    v_fma_f32 v12, -v9, v63, v84
    v_fma_f32 v13, v9, v62, v85
    v_fma_f32 v12, v8, v62, v12
    v_fma_f32 v63, v8, v63, v13
    v_mov_b32 v62, v12
    s_cmp_le_u32 s3, 2
    s_cbranch_scc1 L_waves_done_57
    v_fma_f32 v12, -v9, v63, v86
    v_fma_f32 v13, v9, v62, v87
    v_fma_f32 v12, v8, v62, v12
    v_fma_f32 v63, v8, v63, v13
    v_mov_b32 v62, v12
L_waves_done_57:
    v_fma_f32 v12, -v7, v63, v54
    v_fma_f32 v13, v7, v62, v55
    v_fma_f32 v12, v6, v62, v12
    v_fma_f32 v15, v6, v63, v13
    v_mov_b32 v14, v12
    v_cmp_lt_u32 vcc, 31, v0
    s_nop 1
    v_cndmask_b32 v62, v62, v14, vcc
    v_cndmask_b32 v63, v63, v15, vcc
    v_lshrrev_b32 v16, 5, v0
    v_mul_u32_u24 v16, 34816, v16
    v_and_b32 v17, 31, v0
    v_lshl_add_u32 v60, v17, 2, v16
    s_lshl_b32 s36, s32, 7
    s_lshl_b32 s37, s3, 5
    s_add_u32 s36, s36, s37
    s_mul_i32 s36, s36, 2176
    s_lshl_b32 s37, s33, 7
    s_add_u32 s36, s36, s37
    s_add_u32 s36, s36, 6291456
    v_fma_f32 v12, -v3, v63, v20
    v_fma_f32 v13, v3, v62, v36
    v_fma_f32 v20, v2, v62, v12
    v_fma_f32 v36, v2, v63, v13
    v_cvt_pk_bf16_f32 v64, v20, v36
    buffer_store_dword v64, v60, s[16:19], s36 offen sc1
    v_fma_f32 v12, -v3, v36, v21
    v_fma_f32 v13, v3, v20, v37
    v_fma_f32 v21, v2, v20, v12
    v_fma_f32 v37, v2, v36, v13
    v_cvt_pk_bf16_f32 v65, v21, v37
    buffer_store_dword v65, v60, s[16:19], s36 offen offset:2176 sc1
    s_add_u32 s36, s36, 4352
    v_fma_f32 v12, -v3, v37, v22
    v_fma_f32 v13, v3, v21, v38
    v_fma_f32 v22, v2, v21, v12
    v_fma_f32 v38, v2, v37, v13
    v_cvt_pk_bf16_f32 v66, v22, v38
    buffer_store_dword v66, v60, s[16:19], s36 offen sc1
    v_fma_f32 v12, -v3, v38, v23
    v_fma_f32 v13, v3, v22, v39
    v_fma_f32 v23, v2, v22, v12
    v_fma_f32 v39, v2, v38, v13
    v_cvt_pk_bf16_f32 v67, v23, v39
    buffer_store_dword v67, v60, s[16:19], s36 offen offset:2176 sc1
    s_add_u32 s36, s36, 4352
    v_fma_f32 v12, -v3, v39, v24
    v_fma_f32 v13, v3, v23, v40
    v_fma_f32 v24, v2, v23, v12
    v_fma_f32 v40, v2, v39, v13
    v_cvt_pk_bf16_f32 v68, v24, v40
    buffer_store_dword v68, v60, s[16:19], s36 offen sc1
    v_fma_f32 v12, -v3, v40, v25
    v_fma_f32 v13, v3, v24, v41
    v_fma_f32 v25, v2, v24, v12
    v_fma_f32 v41, v2, v40, v13
    v_cvt_pk_bf16_f32 v69, v25, v41
    buffer_store_dword v69, v60, s[16:19], s36 offen offset:2176 sc1
    s_add_u32 s36, s36, 4352
    v_fma_f32 v12, -v3, v41, v26
    v_fma_f32 v13, v3, v25, v42
    v_fma_f32 v26, v2, v25, v12
    v_fma_f32 v42, v2, v41, v13
    v_cvt_pk_bf16_f32 v70, v26, v42
    buffer_store_dword v70, v60, s[16:19], s36 offen sc1
    v_fma_f32 v12, -v3, v42, v27
    v_fma_f32 v13, v3, v26, v43
    v_fma_f32 v27, v2, v26, v12
    v_fma_f32 v43, v2, v42, v13
    v_cvt_pk_bf16_f32 v71, v27, v43
    buffer_store_dword v71, v60, s[16:19], s36 offen offset:2176 sc1
    s_add_u32 s36, s36, 4352
    v_fma_f32 v12, -v3, v43, v28
    v_fma_f32 v13, v3, v27, v44
    v_fma_f32 v28, v2, v27, v12
    v_fma_f32 v44, v2, v43, v13
    v_cvt_pk_bf16_f32 v72, v28, v44
    buffer_store_dword v72, v60, s[16:19], s36 offen sc1
    v_fma_f32 v12, -v3, v44, v29
    v_fma_f32 v13, v3, v28, v45
    v_fma_f32 v29, v2, v28, v12
    v_fma_f32 v45, v2, v44, v13
    v_cvt_pk_bf16_f32 v73, v29, v45
    buffer_store_dword v73, v60, s[16:19], s36 offen offset:2176 sc1
    s_add_u32 s36, s36, 4352
    v_fma_f32 v12, -v3, v45, v30
    v_fma_f32 v13, v3, v29, v46
    v_fma_f32 v30, v2, v29, v12
    v_fma_f32 v46, v2, v45, v13
    v_cvt_pk_bf16_f32 v74, v30, v46
    buffer_store_dword v74, v60, s[16:19], s36 offen sc1
    v_fma_f32 v12, -v3, v46, v31
    v_fma_f32 v13, v3, v30, v47
    v_fma_f32 v31, v2, v30, v12
    v_fma_f32 v47, v2, v46, v13
    v_cvt_pk_bf16_f32 v75, v31, v47
    buffer_store_dword v75, v60, s[16:19], s36 offen offset:2176 sc1
    s_add_u32 s36, s36, 4352
    v_fma_f32 v12, -v3, v47, v32
    v_fma_f32 v13, v3, v31, v48
    v_fma_f32 v32, v2, v31, v12
    v_fma_f32 v48, v2, v47, v13
    v_cvt_pk_bf16_f32 v76, v32, v48
    buffer_store_dword v76, v60, s[16:19], s36 offen sc1
    v_fma_f32 v12, -v3, v48, v33
    v_fma_f32 v13, v3, v32, v49
    v_fma_f32 v33, v2, v32, v12
    v_fma_f32 v49, v2, v48, v13
    v_cvt_pk_bf16_f32 v77, v33, v49
    buffer_store_dword v77, v60, s[16:19], s36 offen offset:2176 sc1
    s_add_u32 s36, s36, 4352
    v_fma_f32 v12, -v3, v49, v34
    v_fma_f32 v13, v3, v33, v50
    v_fma_f32 v34, v2, v33, v12
    v_fma_f32 v50, v2, v49, v13
    v_cvt_pk_bf16_f32 v78, v34, v50
    buffer_store_dword v78, v60, s[16:19], s36 offen sc1
    v_fma_f32 v12, -v3, v50, v35
    v_fma_f32 v13, v3, v34, v51
    v_fma_f32 v35, v2, v34, v12
    v_fma_f32 v51, v2, v50, v13
    v_cvt_pk_bf16_f32 v79, v35, v51
    buffer_store_dword v79, v60, s[16:19], s36 offen offset:2176 sc1
    s_waitcnt vmcnt(0)
    s_barrier
    s_cmp_lg_u32 s3, 0
    s_cbranch_scc1 L_B_f3_58
    s_lshl_b32 s36, s32, 4
    s_add_u32 s36, s36, s33
    s_lshl_b32 s36, s36, 7
    s_add_u32 s36, s36, 12648448
    v_mov_b32 v12, s36
    v_mov_b32 v13, s34
    s_mov_b64 exec, 1
    buffer_store_dword v13, v12, s[16:19], 0 offen sc1
    s_mov_b64 exec, -1
L_B_f3_58:
    s_lshr_b32 s36, s33, 3
    s_lshl_b32 s40, s32, 1
    s_add_u32 s40, s40, s36
    s_and_b32 s41, s33, 7
    s_and_b32 s42, s3, 1
    s_lshr_b32 s43, s3, 1
    v_lshrrev_b32 v2, 5, v0
    v_lshlrev_b32 v2, 12, v2
    v_and_b32 v3, 31, v0
    v_lshl_add_u32 v2, v3, 1, v2
    s_lshl_b32 s36, s40, 6
    s_lshl_b32 s37, s42, 5
    s_add_u32 s36, s36, s37
    s_lshl_b32 s47, s36, 12
    s_lshl_b32 s36, s36, 10
    s_lshl_b32 s37, s41, 7
    s_add_u32 s36, s36, s37
    s_lshl_b32 s38, s43, 6
    s_add_u32 s36, s36, s38
    s_add_u32 s39, s36, 0
    buffer_load_ushort v104, v2, s[8:11], s39 offen
    s_add_u32 s39, s36, 1024
    buffer_load_ushort v105, v2, s[8:11], s39 offen
    s_add_u32 s39, s36, 2048
    buffer_load_ushort v106, v2, s[8:11], s39 offen
    s_add_u32 s39, s36, 3072
    buffer_load_ushort v107, v2, s[8:11], s39 offen
    s_add_u32 s39, s36, 8192
    buffer_load_ushort v108, v2, s[8:11], s39 offen
    s_add_u32 s39, s36, 9216
    buffer_load_ushort v109, v2, s[8:11], s39 offen
    s_add_u32 s39, s36, 10240
    buffer_load_ushort v110, v2, s[8:11], s39 offen
    s_add_u32 s39, s36, 11264
    buffer_load_ushort v111, v2, s[8:11], s39 offen
    s_add_u32 s39, s36, 16384
    buffer_load_ushort v112, v2, s[8:11], s39 offen
    s_add_u32 s39, s36, 17408
    buffer_load_ushort v113, v2, s[8:11], s39 offen
    s_add_u32 s39, s36, 18432
    buffer_load_ushort v114, v2, s[8:11], s39 offen
    s_add_u32 s39, s36, 19456
    buffer_load_ushort v115, v2, s[8:11], s39 offen
    s_add_u32 s39, s36, 24576
    buffer_load_ushort v116, v2, s[8:11], s39 offen
    s_add_u32 s39, s36, 25600
    buffer_load_ushort v117, v2, s[8:11], s39 offen
    s_add_u32 s39, s36, 26624
    buffer_load_ushort v118, v2, s[8:11], s39 offen
    s_add_u32 s39, s36, 27648
    buffer_load_ushort v119, v2, s[8:11], s39 offen
    v_lshlrev_b32 v3, 1, v3
    s_add_u32 s37, s37, s38
    buffer_load_ushort v120, v3, s[68:71], s37 offen
    v_lshrrev_b32 v4, 3, v0
    s_lshl_b32 s37, s3, 4
    s_lshl_b32 s36, s40, 6
    s_add_u32 s36, s36, s37
    v_add_u32 v5, s36, v4
    v_mul_u32_u24 v5, 2176, v5
    v_lshrrev_b32 v2, 4, v0
    v_and_b32 v3, 7, v0
    v_xor_b32 v2, v2, v3
    v_lshlrev_b32 v6, 4, v2
    v_add_u32 v6, v6, v5
    v_lshrrev_b32 v2, 4, v0
    v_add_u32 v2, 4, v2
    v_and_b32 v3, 7, v0
    v_xor_b32 v2, v2, v3
    v_lshlrev_b32 v7, 4, v2
    v_add_u32 v7, v7, v5
    v_add_u32 v7, 16384, v7
    s_lshl_b32 s36, s41, 6
    s_add_u32 s36, s36, s37
    v_add_u32 v5, s36, v4
    v_mul_u32_u24 v5, 2176, v5
    v_lshrrev_b32 v2, 4, v0
    v_and_b32 v3, 7, v0
    v_xor_b32 v2, v2, v3
    v_lshlrev_b32 v8, 4, v2
    v_add_u32 v8, v8, v5
    v_lshrrev_b32 v2, 4, v0
    v_add_u32 v2, 4, v2
    v_and_b32 v3, 7, v0
    v_xor_b32 v2, v2, v3
    v_lshlrev_b32 v9, 4, v2
    v_add_u32 v9, v9, v5
    v_add_u32 v9, 16384, v9
    v_and_b32 v4, 31, v0
    s_lshl_b32 s36, s42, 5
    v_add_u32 v5, s36, v4
    v_bfe_u32 v2, v5, 1, 3
    v_lshrrev_b32 v3, 5, v0
    v_xor_b32 v2, v2, v3
    v_lshlrev_b32 v2, 4, v2
    v_lshl_add_u32 v10, v5, 7, v2
    v_xor_b32 v11, 32, v10
    v_xor_b32 v12, 64, v10
    v_xor_b32 v13, 96, v10
    s_lshl_b32 s36, s43, 5
    v_add_u32 v5, s36, v4
    v_bfe_u32 v2, v5, 1, 3
    v_lshrrev_b32 v3, 5, v0
    v_xor_b32 v2, v2, v3
    v_lshlrev_b32 v2, 4, v2
    v_lshl_add_u32 v14, v5, 7, v2
    v_xor_b32 v15, 32, v14
    v_xor_b32 v16, 64, v14
    v_xor_b32 v17, 96, v14
    v_add_u32 v14, 8192, v14
    v_add_u32 v15, 8192, v15
    v_add_u32 v16, 8192, v16
    v_add_u32 v17, 8192, v17
    v_add_u32 v18, 65536, v10
    v_add_u32 v121, 65536, v14
    v_add_u32 v19, 65536, v11
    v_add_u32 v122, 65536, v15
    v_add_u32 v20, 65536, v12
    v_add_u32 v123, 65536, v16
    v_add_u32 v21, 65536, v13
    v_add_u32 v124, 65536, v17
    v_and_b32 v2, 31, v0
    v_lshlrev_b32 v2, 7, v2
    s_lshl_b32 s36, s41, 12
    s_add_u32 s36, s36, 12648448
    v_add_u32 v2, s36, v2
    s_mov_b32 s35, 400000
L_poll_F5_59:
    buffer_load_dword v3, v2, s[16:19], 0 offen sc1
    s_waitcnt vmcnt(0)
    v_cmp_ne_u32 vcc, s34, v3
    s_nop 4
    s_cbranch_vccz L_polld_F5_60
    s_sub_u32 s35, s35, 1
    s_cmp_lg_u32 s35, 0
    s_cbranch_scc1 L_poll_F5_59
L_polld_F5_60:
    v_and_b32 v2, 15, v0
    v_lshlrev_b32 v2, 7, v2
    s_lshl_b32 s36, s32, 11
    s_add_u32 s36, s36, 12648448
    v_add_u32 v2, s36, v2
    s_mov_b32 s35, 400000
L_poll_F3_61:
    buffer_load_dword v3, v2, s[16:19], 0 offen sc1
    s_waitcnt vmcnt(0)
    v_cmp_ne_u32 vcc, s34, v3
    s_nop 4
    s_cbranch_vccz L_polld_F3_62
    s_sub_u32 s35, s35, 1
    s_cmp_lg_u32 s35, 0
    s_cbranch_scc1 L_poll_F3_61
L_polld_F3_62:
    s_setprio 0
    s_mov_b32 s44, 0
    s_lshl_b32 s45, s3, 11
    v_mov_b32 v88, 0
    v_mov_b32 v89, 0
    v_mov_b32 v90, 0
    v_mov_b32 v91, 0
    v_mov_b32 v92, 0
    v_mov_b32 v93, 0
    v_mov_b32 v94, 0
    v_mov_b32 v95, 0
    v_mov_b32 v96, 0
    v_mov_b32 v97, 0
    v_mov_b32 v98, 0
    v_mov_b32 v99, 0
    v_mov_b32 v100, 0
    v_mov_b32 v101, 0
    v_mov_b32 v102, 0
    v_mov_b32 v103, 0
    s_add_u32 m0, s45, 0
    s_add_u32 s36, s44, 6291456
    s_add_u32 s37, s44, 11010048
    buffer_load_dwordx4 v6, s[16:19], s36 offen sc1 lds
    buffer_load_dwordx4 v7, s[16:19], s36 offen offset:1024 sc1 lds
    s_add_u32 m0, s45, 8192
    s_add_u32 s44, s44, 128
    buffer_load_dwordx4 v8, s[16:19], s37 offen sc1 lds
    buffer_load_dwordx4 v9, s[16:19], s37 offen offset:1024 sc1 lds
    s_add_u32 m0, s45, 16384
    s_add_u32 s36, s44, 6291456
    s_add_u32 s37, s44, 11010048
    buffer_load_dwordx4 v6, s[16:19], s36 offen sc1 lds
    buffer_load_dwordx4 v7, s[16:19], s36 offen offset:1024 sc1 lds
    s_add_u32 m0, s45, 24576
    s_add_u32 s44, s44, 128
    buffer_load_dwordx4 v8, s[16:19], s37 offen sc1 lds
    buffer_load_dwordx4 v9, s[16:19], s37 offen offset:1024 sc1 lds
    s_add_u32 m0, s45, 32768
    s_add_u32 s36, s44, 6291456
    s_add_u32 s37, s44, 11010048
    buffer_load_dwordx4 v6, s[16:19], s36 offen sc1 lds
    buffer_load_dwordx4 v7, s[16:19], s36 offen offset:1024 sc1 lds
    s_add_u32 m0, s45, 40960
    s_add_u32 s44, s44, 128
    buffer_load_dwordx4 v8, s[16:19], s37 offen sc1 lds
    buffer_load_dwordx4 v9, s[16:19], s37 offen offset:1024 sc1 lds
    s_add_u32 m0, s45, 49152
    s_add_u32 s36, s44, 6291456
    s_add_u32 s37, s44, 11010048
    buffer_load_dwordx4 v6, s[16:19], s36 offen sc1 lds
    buffer_load_dwordx4 v7, s[16:19], s36 offen offset:1024 sc1 lds
    s_add_u32 m0, s45, 57344
    s_add_u32 s44, s44, 128
    buffer_load_dwordx4 v8, s[16:19], s37 offen sc1 lds
    buffer_load_dwordx4 v9, s[16:19], s37 offen offset:1024 sc1 lds
    s_add_u32 m0, s45, 65536
    s_add_u32 s36, s44, 6291456
    s_add_u32 s37, s44, 11010048
    buffer_load_dwordx4 v6, s[16:19], s36 offen sc1 lds
    buffer_load_dwordx4 v7, s[16:19], s36 offen offset:1024 sc1 lds
    s_add_u32 m0, s45, 73728
    s_add_u32 s44, s44, 128
    buffer_load_dwordx4 v8, s[16:19], s37 offen sc1 lds
    buffer_load_dwordx4 v9, s[16:19], s37 offen offset:1024 sc1 lds
    s_waitcnt vmcnt(16)
    s_barrier
    ds_read_b128 v[24:27], v10 offset:0
    ds_read_b128 v[40:43], v14 offset:0
    ds_read_b128 v[28:31], v11 offset:0
    ds_read_b128 v[44:47], v15 offset:0
    ds_read_b128 v[32:35], v12 offset:0
    ds_read_b128 v[48:51], v16 offset:0
    ds_read_b128 v[36:39], v13 offset:0
    ds_read_b128 v[52:55], v17 offset:0
    s_waitcnt vmcnt(12) lgkmcnt(0)
    s_barrier
    v_mfma_f32_32x32x16_bf16 v[88:103], v[24:27], v[40:43], v[88:103]
    ds_read_b128 v[56:59], v10 offset:16384
    ds_read_b128 v[72:75], v14 offset:16384
    ds_read_b128 v[60:63], v11 offset:16384
    ds_read_b128 v[76:79], v15 offset:16384
    v_mfma_f32_32x32x16_bf16 v[88:103], v[28:31], v[44:47], v[88:103]
    ds_read_b128 v[64:67], v12 offset:16384
    ds_read_b128 v[80:83], v16 offset:16384
    ds_read_b128 v[68:71], v13 offset:16384
    ds_read_b128 v[84:87], v17 offset:16384
    v_mfma_f32_32x32x16_bf16 v[88:103], v[32:35], v[48:51], v[88:103]
    s_add_u32 m0, s45, 0
    s_add_u32 s36, s44, 6291456
    s_add_u32 s37, s44, 11010048
    buffer_load_dwordx4 v6, s[16:19], s36 offen sc1 lds
    buffer_load_dwordx4 v7, s[16:19], s36 offen offset:1024 sc1 lds
    v_mfma_f32_32x32x16_bf16 v[88:103], v[36:39], v[52:55], v[88:103]
    s_add_u32 m0, s45, 8192
    s_add_u32 s44, s44, 128
    buffer_load_dwordx4 v8, s[16:19], s37 offen sc1 lds
    buffer_load_dwordx4 v9, s[16:19], s37 offen offset:1024 sc1 lds
    s_waitcnt vmcnt(12) lgkmcnt(0)
    s_barrier
    v_mfma_f32_32x32x16_bf16 v[88:103], v[56:59], v[72:75], v[88:103]
    ds_read_b128 v[24:27], v10 offset:32768
    ds_read_b128 v[40:43], v14 offset:32768
    ds_read_b128 v[28:31], v11 offset:32768
    ds_read_b128 v[44:47], v15 offset:32768
    v_mfma_f32_32x32x16_bf16 v[88:103], v[60:63], v[76:79], v[88:103]
    ds_read_b128 v[32:35], v12 offset:32768
    ds_read_b128 v[48:51], v16 offset:32768
    ds_read_b128 v[36:39], v13 offset:32768
    ds_read_b128 v[52:55], v17 offset:32768
    v_mfma_f32_32x32x16_bf16 v[88:103], v[64:67], v[80:83], v[88:103]
    s_add_u32 m0, s45, 16384
    s_add_u32 s36, s44, 6291456
    s_add_u32 s37, s44, 11010048
    buffer_load_dwordx4 v6, s[16:19], s36 offen sc1 lds
    buffer_load_dwordx4 v7, s[16:19], s36 offen offset:1024 sc1 lds
    v_mfma_f32_32x32x16_bf16 v[88:103], v[68:71], v[84:87], v[88:103]
    s_add_u32 m0, s45, 24576
    s_add_u32 s44, s44, 128
    buffer_load_dwordx4 v8, s[16:19], s37 offen sc1 lds
    buffer_load_dwordx4 v9, s[16:19], s37 offen offset:1024 sc1 lds
    s_waitcnt vmcnt(12) lgkmcnt(0)
    s_barrier
    v_mfma_f32_32x32x16_bf16 v[88:103], v[24:27], v[40:43], v[88:103]
    ds_read_b128 v[56:59], v10 offset:49152
    ds_read_b128 v[72:75], v14 offset:49152
    ds_read_b128 v[60:63], v11 offset:49152
    ds_read_b128 v[76:79], v15 offset:49152
    v_mfma_f32_32x32x16_bf16 v[88:103], v[28:31], v[44:47], v[88:103]
    ds_read_b128 v[64:67], v12 offset:49152
    ds_read_b128 v[80:83], v16 offset:49152
    ds_read_b128 v[68:71], v13 offset:49152
    ds_read_b128 v[84:87], v17 offset:49152
    v_mfma_f32_32x32x16_bf16 v[88:103], v[32:35], v[48:51], v[88:103]
    s_add_u32 m0, s45, 32768
    s_add_u32 s36, s44, 6291456
    s_add_u32 s37, s44, 11010048
    buffer_load_dwordx4 v6, s[16:19], s36 offen sc1 lds
    buffer_load_dwordx4 v7, s[16:19], s36 offen offset:1024 sc1 lds
    v_mfma_f32_32x32x16_bf16 v[88:103], v[36:39], v[52:55], v[88:103]
    s_add_u32 m0, s45, 40960
    s_add_u32 s44, s44, 128
    buffer_load_dwordx4 v8, s[16:19], s37 offen sc1 lds
    buffer_load_dwordx4 v9, s[16:19], s37 offen offset:1024 sc1 lds
    s_waitcnt vmcnt(12) lgkmcnt(0)
    s_barrier
    v_mfma_f32_32x32x16_bf16 v[88:103], v[56:59], v[72:75], v[88:103]
    ds_read_b128 v[24:27], v18
    ds_read_b128 v[40:43], v121
    ds_read_b128 v[28:31], v19
    ds_read_b128 v[44:47], v122
    v_mfma_f32_32x32x16_bf16 v[88:103], v[60:63], v[76:79], v[88:103]
    ds_read_b128 v[32:35], v20
    ds_read_b128 v[48:51], v123
    ds_read_b128 v[36:39], v21
    ds_read_b128 v[52:55], v124
    v_mfma_f32_32x32x16_bf16 v[88:103], v[64:67], v[80:83], v[88:103]
    s_add_u32 m0, s45, 49152
    s_add_u32 s36, s44, 6291456
    s_add_u32 s37, s44, 11010048
    buffer_load_dwordx4 v6, s[16:19], s36 offen sc1 lds
    buffer_load_dwordx4 v7, s[16:19], s36 offen offset:1024 sc1 lds
    v_mfma_f32_32x32x16_bf16 v[88:103], v[68:71], v[84:87], v[88:103]
    s_add_u32 m0, s45, 57344
    s_add_u32 s44, s44, 128
    buffer_load_dwordx4 v8, s[16:19], s37 offen sc1 lds
    buffer_load_dwordx4 v9, s[16:19], s37 offen offset:1024 sc1 lds
    s_waitcnt vmcnt(12) lgkmcnt(0)
    s_barrier
    v_mfma_f32_32x32x16_bf16 v[88:103], v[24:27], v[40:43], v[88:103]
    ds_read_b128 v[56:59], v10 offset:0
    ds_read_b128 v[72:75], v14 offset:0
    ds_read_b128 v[60:63], v11 offset:0
    ds_read_b128 v[76:79], v15 offset:0
    v_mfma_f32_32x32x16_bf16 v[88:103], v[28:31], v[44:47], v[88:103]
    ds_read_b128 v[64:67], v12 offset:0
    ds_read_b128 v[80:83], v16 offset:0
    ds_read_b128 v[68:71], v13 offset:0
    ds_read_b128 v[84:87], v17 offset:0
    v_mfma_f32_32x32x16_bf16 v[88:103], v[32:35], v[48:51], v[88:103]
    s_add_u32 m0, s45, 65536
    s_add_u32 s36, s44, 6291456
    s_add_u32 s37, s44, 11010048
    buffer_load_dwordx4 v6, s[16:19], s36 offen sc1 lds
    buffer_load_dwordx4 v7, s[16:19], s36 offen offset:1024 sc1 lds
    v_mfma_f32_32x32x16_bf16 v[88:103], v[36:39], v[52:55], v[88:103]
    s_add_u32 m0, s45, 73728
    s_add_u32 s44, s44, 128
    buffer_load_dwordx4 v8, s[16:19], s37 offen sc1 lds
    buffer_load_dwordx4 v9, s[16:19], s37 offen offset:1024 sc1 lds
    s_waitcnt vmcnt(12) lgkmcnt(0)
    s_barrier
    v_mfma_f32_32x32x16_bf16 v[88:103], v[56:59], v[72:75], v[88:103]
    ds_read_b128 v[24:27], v10 offset:16384
    ds_read_b128 v[40:43], v14 offset:16384
    ds_read_b128 v[28:31], v11 offset:16384
    ds_read_b128 v[44:47], v15 offset:16384
    v_mfma_f32_32x32x16_bf16 v[88:103], v[60:63], v[76:79], v[88:103]
    ds_read_b128 v[32:35], v12 offset:16384
    ds_read_b128 v[48:51], v16 offset:16384
    ds_read_b128 v[36:39], v13 offset:16384
    ds_read_b128 v[52:55], v17 offset:16384
    v_mfma_f32_32x32x16_bf16 v[88:103], v[64:67], v[80:83], v[88:103]
    s_add_u32 m0, s45, 0
    s_add_u32 s36, s44, 6291456
    s_add_u32 s37, s44, 11010048
    buffer_load_dwordx4 v6, s[16:19], s36 offen sc1 lds
    buffer_load_dwordx4 v7, s[16:19], s36 offen offset:1024 sc1 lds
    v_mfma_f32_32x32x16_bf16 v[88:103], v[68:71], v[84:87], v[88:103]
    s_add_u32 m0, s45, 8192
    s_add_u32 s44, s44, 128
    buffer_load_dwordx4 v8, s[16:19], s37 offen sc1 lds
    buffer_load_dwordx4 v9, s[16:19], s37 offen offset:1024 sc1 lds
    s_waitcnt vmcnt(12) lgkmcnt(0)
    s_barrier
    v_mfma_f32_32x32x16_bf16 v[88:103], v[24:27], v[40:43], v[88:103]
    ds_read_b128 v[56:59], v10 offset:32768
    ds_read_b128 v[72:75], v14 offset:32768
    ds_read_b128 v[60:63], v11 offset:32768
    ds_read_b128 v[76:79], v15 offset:32768
    v_mfma_f32_32x32x16_bf16 v[88:103], v[28:31], v[44:47], v[88:103]
    ds_read_b128 v[64:67], v12 offset:32768
    ds_read_b128 v[80:83], v16 offset:32768
    ds_read_b128 v[68:71], v13 offset:32768
    ds_read_b128 v[84:87], v17 offset:32768
    v_mfma_f32_32x32x16_bf16 v[88:103], v[32:35], v[48:51], v[88:103]
    s_add_u32 m0, s45, 16384
    s_add_u32 s36, s44, 6291456
    s_add_u32 s37, s44, 11010048
    buffer_load_dwordx4 v6, s[16:19], s36 offen sc1 lds
    buffer_load_dwordx4 v7, s[16:19], s36 offen offset:1024 sc1 lds
    v_mfma_f32_32x32x16_bf16 v[88:103], v[36:39], v[52:55], v[88:103]
    s_add_u32 m0, s45, 24576
    s_add_u32 s44, s44, 128
    buffer_load_dwordx4 v8, s[16:19], s37 offen sc1 lds
    buffer_load_dwordx4 v9, s[16:19], s37 offen offset:1024 sc1 lds
    s_waitcnt vmcnt(12) lgkmcnt(0)
    s_barrier
    v_mfma_f32_32x32x16_bf16 v[88:103], v[56:59], v[72:75], v[88:103]
    ds_read_b128 v[24:27], v10 offset:49152
    ds_read_b128 v[40:43], v14 offset:49152
    ds_read_b128 v[28:31], v11 offset:49152
    ds_read_b128 v[44:47], v15 offset:49152
    v_mfma_f32_32x32x16_bf16 v[88:103], v[60:63], v[76:79], v[88:103]
    ds_read_b128 v[32:35], v12 offset:49152
    ds_read_b128 v[48:51], v16 offset:49152
    ds_read_b128 v[36:39], v13 offset:49152
    ds_read_b128 v[52:55], v17 offset:49152
    v_mfma_f32_32x32x16_bf16 v[88:103], v[64:67], v[80:83], v[88:103]
    s_add_u32 m0, s45, 32768
    s_add_u32 s36, s44, 6291456
    s_add_u32 s37, s44, 11010048
    buffer_load_dwordx4 v6, s[16:19], s36 offen sc1 lds
    buffer_load_dwordx4 v7, s[16:19], s36 offen offset:1024 sc1 lds
    v_mfma_f32_32x32x16_bf16 v[88:103], v[68:71], v[84:87], v[88:103]
    s_add_u32 m0, s45, 40960
    s_add_u32 s44, s44, 128
    buffer_load_dwordx4 v8, s[16:19], s37 offen sc1 lds
    buffer_load_dwordx4 v9, s[16:19], s37 offen offset:1024 sc1 lds
    s_waitcnt vmcnt(12) lgkmcnt(0)
    s_barrier
    v_mfma_f32_32x32x16_bf16 v[88:103], v[24:27], v[40:43], v[88:103]
    ds_read_b128 v[56:59], v18
    ds_read_b128 v[72:75], v121
    ds_read_b128 v[60:63], v19
    ds_read_b128 v[76:79], v122
    v_mfma_f32_32x32x16_bf16 v[88:103], v[28:31], v[44:47], v[88:103]
    ds_read_b128 v[64:67], v20
    ds_read_b128 v[80:83], v123
    ds_read_b128 v[68:71], v21
    ds_read_b128 v[84:87], v124
    v_mfma_f32_32x32x16_bf16 v[88:103], v[32:35], v[48:51], v[88:103]
    s_add_u32 m0, s45, 49152
    s_add_u32 s36, s44, 6291456
    s_add_u32 s37, s44, 11010048
    buffer_load_dwordx4 v6, s[16:19], s36 offen sc1 lds
    buffer_load_dwordx4 v7, s[16:19], s36 offen offset:1024 sc1 lds
    v_mfma_f32_32x32x16_bf16 v[88:103], v[36:39], v[52:55], v[88:103]
    s_add_u32 m0, s45, 57344
    s_add_u32 s44, s44, 128
    buffer_load_dwordx4 v8, s[16:19], s37 offen sc1 lds
    buffer_load_dwordx4 v9, s[16:19], s37 offen offset:1024 sc1 lds
    s_waitcnt vmcnt(12) lgkmcnt(0)
    s_barrier
    v_mfma_f32_32x32x16_bf16 v[88:103], v[56:59], v[72:75], v[88:103]
    ds_read_b128 v[24:27], v10 offset:0
    ds_read_b128 v[40:43], v14 offset:0
    ds_read_b128 v[28:31], v11 offset:0
    ds_read_b128 v[44:47], v15 offset:0
    v_mfma_f32_32x32x16_bf16 v[88:103], v[60:63], v[76:79], v[88:103]
    ds_read_b128 v[32:35], v12 offset:0
    ds_read_b128 v[48:51], v16 offset:0
    ds_read_b128 v[36:39], v13 offset:0
    ds_read_b128 v[52:55], v17 offset:0
    v_mfma_f32_32x32x16_bf16 v[88:103], v[64:67], v[80:83], v[88:103]
    s_add_u32 m0, s45, 65536
    s_add_u32 s36, s44, 6291456
    s_add_u32 s37, s44, 11010048
    buffer_load_dwordx4 v6, s[16:19], s36 offen sc1 lds
    buffer_load_dwordx4 v7, s[16:19], s36 offen offset:1024 sc1 lds
    v_mfma_f32_32x32x16_bf16 v[88:103], v[68:71], v[84:87], v[88:103]
    s_add_u32 m0, s45, 73728
    s_add_u32 s44, s44, 128
    buffer_load_dwordx4 v8, s[16:19], s37 offen sc1 lds
    buffer_load_dwordx4 v9, s[16:19], s37 offen offset:1024 sc1 lds
    s_waitcnt vmcnt(12) lgkmcnt(0)
    s_barrier
    v_mfma_f32_32x32x16_bf16 v[88:103], v[24:27], v[40:43], v[88:103]
    ds_read_b128 v[56:59], v10 offset:16384
    ds_read_b128 v[72:75], v14 offset:16384
    ds_read_b128 v[60:63], v11 offset:16384
    ds_read_b128 v[76:79], v15 offset:16384
    v_mfma_f32_32x32x16_bf16 v[88:103], v[28:31], v[44:47], v[88:103]
    ds_read_b128 v[64:67], v12 offset:16384
    ds_read_b128 v[80:83], v16 offset:16384
    ds_read_b128 v[68:71], v13 offset:16384
    ds_read_b128 v[84:87], v17 offset:16384
    v_mfma_f32_32x32x16_bf16 v[88:103], v[32:35], v[48:51], v[88:103]
    s_add_u32 m0, s45, 0
    s_add_u32 s36, s44, 6291456
    s_add_u32 s37, s44, 11010048
    buffer_load_dwordx4 v6, s[16:19], s36 offen sc1 lds
    buffer_load_dwordx4 v7, s[16:19], s36 offen offset:1024 sc1 lds
    v_mfma_f32_32x32x16_bf16 v[88:103], v[36:39], v[52:55], v[88:103]
    s_add_u32 m0, s45, 8192
    s_add_u32 s44, s44, 128
    buffer_load_dwordx4 v8, s[16:19], s37 offen sc1 lds
    buffer_load_dwordx4 v9, s[16:19], s37 offen offset:1024 sc1 lds
    s_waitcnt vmcnt(12) lgkmcnt(0)
    s_barrier
    v_mfma_f32_32x32x16_bf16 v[88:103], v[56:59], v[72:75], v[88:103]
    ds_read_b128 v[24:27], v10 offset:32768
    ds_read_b128 v[40:43], v14 offset:32768
    ds_read_b128 v[28:31], v11 offset:32768
    ds_read_b128 v[44:47], v15 offset:32768
    v_mfma_f32_32x32x16_bf16 v[88:103], v[60:63], v[76:79], v[88:103]
    ds_read_b128 v[32:35], v12 offset:32768
    ds_read_b128 v[48:51], v16 offset:32768
    ds_read_b128 v[36:39], v13 offset:32768
    ds_read_b128 v[52:55], v17 offset:32768
    v_mfma_f32_32x32x16_bf16 v[88:103], v[64:67], v[80:83], v[88:103]
    v_mfma_f32_32x32x16_bf16 v[88:103], v[68:71], v[84:87], v[88:103]
    s_waitcnt vmcnt(8) lgkmcnt(0)
    s_barrier
    v_mfma_f32_32x32x16_bf16 v[88:103], v[24:27], v[40:43], v[88:103]
    ds_read_b128 v[56:59], v10 offset:49152
    ds_read_b128 v[72:75], v14 offset:49152
    ds_read_b128 v[60:63], v11 offset:49152
    ds_read_b128 v[76:79], v15 offset:49152
    v_mfma_f32_32x32x16_bf16 v[88:103], v[28:31], v[44:47], v[88:103]
    ds_read_b128 v[64:67], v12 offset:49152
    ds_read_b128 v[80:83], v16 offset:49152
    ds_read_b128 v[68:71], v13 offset:49152
    ds_read_b128 v[84:87], v17 offset:49152
    v_mfma_f32_32x32x16_bf16 v[88:103], v[32:35], v[48:51], v[88:103]
    v_mfma_f32_32x32x16_bf16 v[88:103], v[36:39], v[52:55], v[88:103]
    s_waitcnt vmcnt(4) lgkmcnt(0)
    s_barrier
    v_mfma_f32_32x32x16_bf16 v[88:103], v[56:59], v[72:75], v[88:103]
    ds_read_b128 v[24:27], v18
    ds_read_b128 v[40:43], v121
    ds_read_b128 v[28:31], v19
    ds_read_b128 v[44:47], v122
    v_mfma_f32_32x32x16_bf16 v[88:103], v[60:63], v[76:79], v[88:103]
    ds_read_b128 v[32:35], v20
    ds_read_b128 v[48:51], v123
    ds_read_b128 v[36:39], v21
    ds_read_b128 v[52:55], v124
    v_mfma_f32_32x32x16_bf16 v[88:103], v[64:67], v[80:83], v[88:103]
    v_mfma_f32_32x32x16_bf16 v[88:103], v[68:71], v[84:87], v[88:103]
    s_waitcnt vmcnt(0) lgkmcnt(0)
    s_barrier
    v_mfma_f32_32x32x16_bf16 v[88:103], v[24:27], v[40:43], v[88:103]
    ds_read_b128 v[56:59], v10 offset:0
    ds_read_b128 v[72:75], v14 offset:0
    ds_read_b128 v[60:63], v11 offset:0
    ds_read_b128 v[76:79], v15 offset:0
    v_mfma_f32_32x32x16_bf16 v[88:103], v[28:31], v[44:47], v[88:103]
    ds_read_b128 v[64:67], v12 offset:0
    ds_read_b128 v[80:83], v16 offset:0
    ds_read_b128 v[68:71], v13 offset:0
    ds_read_b128 v[84:87], v17 offset:0
    v_mfma_f32_32x32x16_bf16 v[88:103], v[32:35], v[48:51], v[88:103]
    v_mfma_f32_32x32x16_bf16 v[88:103], v[36:39], v[52:55], v[88:103]
    s_waitcnt lgkmcnt(0)
    v_mfma_f32_32x32x16_bf16 v[88:103], v[56:59], v[72:75], v[88:103]
    v_mfma_f32_32x32x16_bf16 v[88:103], v[60:63], v[76:79], v[88:103]
    v_mfma_f32_32x32x16_bf16 v[88:103], v[64:67], v[80:83], v[88:103]
    v_mfma_f32_32x32x16_bf16 v[88:103], v[68:71], v[84:87], v[88:103]
    v_lshrrev_b32 v2, 5, v0
    v_lshlrev_b32 v2, 14, v2
    v_and_b32 v3, 31, v0
    v_lshl_add_u32 v2, v3, 2, v2
    s_lshl_b32 s36, s41, 8
    s_add_u32 s36, s36, s47
    s_lshl_b32 s37, s43, 7
    s_add_u32 s36, s36, s37
    s_add_u32 s36, s36, 2048
    v_lshlrev_b32 v120, 16, v120
    v_lshlrev_b32 v104, 16, v104
    v_lshlrev_b32 v105, 16, v105
    v_lshlrev_b32 v106, 16, v106
    v_lshlrev_b32 v107, 16, v107
    v_lshlrev_b32 v108, 16, v108
    v_lshlrev_b32 v109, 16, v109
    v_lshlrev_b32 v110, 16, v110
    v_lshlrev_b32 v111, 16, v111
    v_lshlrev_b32 v112, 16, v112
    v_lshlrev_b32 v113, 16, v113
    v_lshlrev_b32 v114, 16, v114
    v_lshlrev_b32 v115, 16, v115
    v_lshlrev_b32 v116, 16, v116
    v_lshlrev_b32 v117, 16, v117
    v_lshlrev_b32 v118, 16, v118
    v_lshlrev_b32 v119, 16, v119
    s_nop 1
    v_fma_f32 v88, v104, v120, v88
    v_fma_f32 v89, v105, v120, v89
    v_fma_f32 v90, v106, v120, v90
    v_fma_f32 v91, v107, v120, v91
    v_fma_f32 v92, v108, v120, v92
    v_fma_f32 v93, v109, v120, v93
    v_fma_f32 v94, v110, v120, v94
    v_fma_f32 v95, v111, v120, v95
    v_fma_f32 v96, v112, v120, v96
    v_fma_f32 v97, v113, v120, v97
    v_fma_f32 v98, v114, v120, v98
    v_fma_f32 v99, v115, v120, v99
    v_fma_f32 v100, v116, v120, v100
    v_fma_f32 v101, v117, v120, v101
    v_fma_f32 v102, v118, v120, v102
    v_fma_f32 v103, v119, v120, v103
    s_add_u32 s37, s36, 0
    buffer_store_dword v88, v2, s[24:27], s37 offen nt
    s_add_u32 s37, s36, 4096
    buffer_store_dword v89, v2, s[24:27], s37 offen nt
    s_add_u32 s37, s36, 8192
    buffer_store_dword v90, v2, s[24:27], s37 offen nt
    s_add_u32 s37, s36, 12288
    buffer_store_dword v91, v2, s[24:27], s37 offen nt
    s_add_u32 s37, s36, 32768
    buffer_store_dword v92, v2, s[24:27], s37 offen nt
    s_add_u32 s37, s36, 36864
    buffer_store_dword v93, v2, s[24:27], s37 offen nt
    s_add_u32 s37, s36, 40960
    buffer_store_dword v94, v2, s[24:27], s37 offen nt
    s_add_u32 s37, s36, 45056
    buffer_store_dword v95, v2, s[24:27], s37 offen nt
    s_add_u32 s37, s36, 65536
    buffer_store_dword v96, v2, s[24:27], s37 offen nt
    s_add_u32 s37, s36, 69632
    buffer_store_dword v97, v2, s[24:27], s37 offen nt
    s_add_u32 s37, s36, 73728
    buffer_store_dword v98, v2, s[24:27], s37 offen nt
    s_add_u32 s37, s36, 77824
    buffer_store_dword v99, v2, s[24:27], s37 offen nt
    s_add_u32 s37, s36, 98304
    buffer_store_dword v100, v2, s[24:27], s37 offen nt
    s_add_u32 s37, s36, 102400
    buffer_store_dword v101, v2, s[24:27], s37 offen nt
    s_add_u32 s37, s36, 106496
    buffer_store_dword v102, v2, s[24:27], s37 offen nt
    s_add_u32 s37, s36, 110592
    buffer_store_dword v103, v2, s[24:27], s37 offen nt
L_end:
    s_endpgm
.section .rodata,"a"
.p2align 6
.amdhsa_kernel concat_heads__softmax_full_mha__ssm_conv_s5__prompt_kernel
  .amdhsa_next_free_vgpr 128
  .amdhsa_next_free_sgpr 96
  .amdhsa_accum_offset 128
  .amdhsa_group_segment_fixed_size 0
  .amdhsa_kernarg_size 120
  .amdhsa_user_sgpr_count 2
  .amdhsa_user_sgpr_kernarg_segment_ptr 1
  .amdhsa_system_sgpr_workgroup_id_x 1
  .amdhsa_float_denorm_mode_32 3
.end_amdhsa_kernel
```
